```python
import torch

def _softmax(x, axis=-1):
    return torch.softmax(x, dim=axis)
def _gelu(x):
    return torch.nn.functional.gelu(x, approximate="tanh")
def _silu(x):
    return torch.nn.functional.silu(x)
def _sigmoid(x):
    return torch.sigmoid(x)
def _layernorm(x, axis=-1, eps=1e-5):
    m = x.mean(dim=axis, keepdim=True)
    v = x.var(dim=axis, keepdim=True, unbiased=False)
    return (x - m) / torch.sqrt(v + eps)
def _scatter_add(tgt, idx, src, axis=0):
    return tgt.clone().index_add_(axis, idx, src)
def _segment_sum(src, seg, n):
    out = torch.zeros((n,) + src.shape[1:], dtype=src.dtype)
    return out.index_add_(0, seg, src)
def _pad(x, pw):
    flat = tuple(v for pair in reversed(pw) for v in pair)
    return torch.nn.functional.pad(x, flat)

kernel_name = 'concat_heads__gqa_block_cached__gqa_block_cached__near_ridge'

def setup_inputs():

    _w = (lambda a: (lambda t: t.to(torch.bfloat16) if t.is_floating_point() else t)(torch.as_tensor(a)))
    def _A_setup():
        B, Sq, D = 8, 96, 448
        Hq, Hkv, Sk, Dh = 16, 8, 1024, 256
        assert Hq % Hkv == 0, (Hq, Hkv)
        return {
            "x": _w((lambda *s: torch.randn(*s, dtype=torch.bfloat16) * 0.8)(B, Sq, D)),
            "k_cache": _w((lambda *s: torch.randn(*s, dtype=torch.bfloat16) * 0.8)(B, Hkv, Sk, Dh)),
            "v_cache": _w((lambda *s: torch.randn(*s, dtype=torch.bfloat16) * 0.05)(B, Hkv, Sk, Dh)),
            "wq": _w((lambda *s: torch.randn(*s, dtype=torch.bfloat16) * 0.8)(D, Hq * Dh) * (D ** -0.5)),
            "wo": _w((lambda *s: torch.randn(*s, dtype=torch.bfloat16) * 0.05)(Hq * Dh, D) * ((Hq * Dh) ** -0.5)),
        }
    _A_in = _A_setup()

    def _B_setup():
        B, Sq, D = 8, 96, 448
        Hq, Hkv, Sk, Dh = 16, 8, 1024, 256
        assert Hq % Hkv == 0, (Hq, Hkv)
        return {
            "x": _w((lambda *s: torch.randn(*s, dtype=torch.bfloat16) * 0.8)(B, Sq, D)),
            "k_cache": _w((lambda *s: torch.randn(*s, dtype=torch.bfloat16) * 0.8)(B, Hkv, Sk, Dh)),
            "v_cache": _w((lambda *s: torch.randn(*s, dtype=torch.bfloat16) * 0.05)(B, Hkv, Sk, Dh)),
            "wq": _w((lambda *s: torch.randn(*s, dtype=torch.bfloat16) * 0.8)(D, Hq * Dh) * (D ** -0.5)),
            "wo": _w((lambda *s: torch.randn(*s, dtype=torch.bfloat16) * 0.05)(Hq * Dh, D) * ((Hq * Dh) ** -0.5)),
        }
    _B_in = _B_setup()

    return {
        "A_x": _A_in["x"],
        "A_k_cache": _A_in["k_cache"],
        "A_v_cache": _A_in["v_cache"],
        "A_wq": _A_in["wq"],
        "A_wo": _A_in["wo"],
        "B_x": _B_in["x"],
        "B_k_cache": _B_in["k_cache"],
        "B_v_cache": _B_in["v_cache"],
        "B_wq": _B_in["wq"],
        "B_wo": _B_in["wo"],
    }

def reference(A_x, A_k_cache, A_v_cache, A_wq, A_wo, B_x, B_k_cache, B_v_cache, B_wq, B_wo):
    def _A_ref(x, k_cache, v_cache, wq, wo):
        B, Sq, D = x.shape
        Hq, Dh = 16, 256
        Hkv = k_cache.shape[1]
        rep = Hq // Hkv
        q = (lambda x, *d: x.permute(*d))((x @ wq).reshape(B, Sq, Hq, Dh), 0, 2, 1, 3)
        k = (lambda x, n, axis: torch.repeat_interleave(x, n, dim=axis))(k_cache, rep, axis=1)
        v = (lambda x, n, axis: torch.repeat_interleave(x, n, dim=axis))(v_cache, rep, axis=1)
        scores = torch.einsum("bhqd,bhkd->bhqk", q, k) * (Dh ** -0.5)
        p = _softmax(scores, axis=-1)
        o = torch.einsum("bhqk,bhkd->bhqd", p, v)
        return (lambda x, *d: x.permute(*d))(o, 0, 2, 1, 3).reshape(B, Sq, Hq * Dh) @ wo

    def _B_ref(x, k_cache, v_cache, wq, wo):
        B, Sq, D = x.shape
        Hq, Dh = 16, 256
        Hkv = k_cache.shape[1]
        rep = Hq // Hkv
        q = (lambda x, *d: x.permute(*d))((x @ wq).reshape(B, Sq, Hq, Dh), 0, 2, 1, 3)
        k = (lambda x, n, axis: torch.repeat_interleave(x, n, dim=axis))(k_cache, rep, axis=1)
        v = (lambda x, n, axis: torch.repeat_interleave(x, n, dim=axis))(v_cache, rep, axis=1)
        scores = torch.einsum("bhqd,bhkd->bhqk", q, k) * (Dh ** -0.5)
        p = _softmax(scores, axis=-1)
        o = torch.einsum("bhqk,bhkd->bhqd", p, v)
        return (lambda x, *d: x.permute(*d))(o, 0, 2, 1, 3).reshape(B, Sq, Hq * Dh) @ wo

    a = _A_ref(A_x, A_k_cache, A_v_cache, A_wq, A_wo)
    b = _B_ref(B_x, B_k_cache, B_v_cache, B_wq, B_wo)
    return torch.concatenate([a, b], axis=-1)
```

```asm
; @launch kernel=concat_heads__gqa_block_cached__gqa_block_cached__near_ridge_kernel grid=(256,1,1) block=(256,1,1) lds=131072
; @launch kernel=oproj_kernel grid=(224,1,1) block=(256,1,1) lds=32832
.amdgcn_target "amdgcn-amd-amdhsa--gfx950"
.text
.globl concat_heads__gqa_block_cached__gqa_block_cached__near_ridge_kernel
.p2align 8
.type concat_heads__gqa_block_cached__gqa_block_cached__near_ridge_kernel,@function
concat_heads__gqa_block_cached__gqa_block_cached__near_ridge_kernel:
    s_cmp_ge_u32 s2, 256
    s_cbranch_scc1 L_attn_end
    v_lshrrev_b32 v2, 6, v0
    v_and_b32 v1, 63, v0
    s_nop 0
    v_readfirstlane_b32 s3, v2
    s_and_b32 s6, s2, 7
    s_lshr_b32 s46, s2, 3
    s_and_b32 s46, s46, 1
    s_lshl_b32 s7, s6, 1
    s_add_u32 s7, s7, s46
    s_lshr_b32 s5, s2, 4
    s_and_b32 s5, s5, 7
    s_lshr_b32 s4, s2, 7
    s_mul_i32 s46, s4, 40
    s_add_u32 s28, s0, s46
    s_addc_u32 s29, s1, 0
    s_load_dwordx8 s[32:39], s[28:29], 0
    s_load_dwordx2 s[40:41], s[0:1], 96
    s_mov_b32 s42, 0x3db8aa3b
    s_mov_b32 s50, 0x42b17218
    v_lshrrev_b32 v2, 5, v1
    v_and_b32 v3, 31, v1
    s_waitcnt lgkmcnt(0)
    s_mul_i32 s46, s5, 86016
    s_add_u32 s20, s32, s46
    s_addc_u32 s21, s33, 0
    s_mov_b32 s22, 86016
    s_mov_b32 s23, 0x00020000
    s_lshl_b32 s46, s5, 3
    s_add_u32 s46, s46, s6
    s_lshl_b32 s46, s46, 19
    s_add_u32 s12, s34, s46
    s_addc_u32 s13, s35, 0
    s_mov_b32 s14, 524288
    s_mov_b32 s15, 0x00020000
    s_add_u32 s16, s36, s46
    s_addc_u32 s17, s37, 0
    s_mov_b32 s18, 524288
    s_mov_b32 s19, 0x00020000
    s_lshl_b32 s46, s7, 9
    s_add_u32 s8, s38, s46
    s_addc_u32 s9, s39, 0
    s_sub_u32 s10, 3670016, s46
    s_mov_b32 s11, 0x00020000
    s_lshl_b32 s46, s4, 3
    s_add_u32 s46, s46, s5
    s_mul_i32 s46, s46, 3
    s_add_u32 s46, s46, s3
    s_lshl_b32 s46, s46, 18
    s_lshl_b32 s47, s7, 14
    s_add_u32 s46, s46, s47
    s_add_u32 s24, s40, s46
    s_addc_u32 s25, s41, 0
    s_mov_b32 s26, 16384
    s_mov_b32 s27, 0x00020000
    v_xor_b32 v4, v3, v2
    v_lshlrev_b32 v4, 4, v4
    v_lshl_add_u32 v4, v2, 9, v4
    s_and_b32 s46, s3, 1
    s_lshl_b32 s46, s46, 7
    v_xor_b32 v4, s46, v4
    s_lshl_b32 s46, s3, 12
    v_add_u32 v4, s46, v4
    v_xor_b32 v12, 0, v4
    v_xor_b32 v13, 32, v4
    v_xor_b32 v14, 64, v4
    v_xor_b32 v15, 96, v4
    v_lshlrev_b32 v5, 2, v2
    v_xor_b32 v5, v3, v5
    v_lshlrev_b32 v5, 4, v5
    v_lshl_add_u32 v6, v2, 9, v5
    v_add_u32 v16, s46, v6
    v_xor_b32 v17, 128, v16
    v_lshl_add_u32 v6, v2, 13, v5
    s_lshl_b32 s46, s3, 16
    v_add_u32 v18, s46, v6
    v_xor_b32 v19, 128, v18
    v_and_b32 v6, 15, v3
    v_xor_b32 v6, v6, v2
    v_lshlrev_b32 v6, 4, v6
    v_lshl_add_u32 v6, v3, 9, v6
    v_xor_b32 v20, 0, v6
    v_xor_b32 v21, 32, v6
    v_xor_b32 v22, 64, v6
    v_xor_b32 v23, 96, v6
    v_xor_b32 v24, 128, v6
    v_xor_b32 v25, 160, v6
    v_xor_b32 v26, 192, v6
    v_xor_b32 v27, 224, v6
    v_bfe_u32 v6, v1, 2, 2
    v_lshl_add_u32 v7, v2, 2, v6
    v_lshlrev_b32 v7, 9, v7
    v_bfe_u32 v8, v1, 4, 1
    v_lshl_add_u32 v7, v8, 5, v7
    v_and_b32 v8, 3, v1
    v_lshl_add_u32 v7, v8, 3, v7
    v_add_u32 v7, 65536, v7
    v_xor_b32 v8, 0, v6
    v_lshl_add_u32 v28, v8, 6, v7
    v_subrev_u32 v100, 65536, v28
    v_xor_b32 v8, 1, v6
    v_lshl_add_u32 v29, v8, 6, v7
    v_subrev_u32 v101, 65536, v29
    v_xor_b32 v8, 2, v6
    v_lshl_add_u32 v30, v8, 6, v7
    v_subrev_u32 v102, 65536, v30
    v_xor_b32 v8, 3, v6
    v_lshl_add_u32 v31, v8, 6, v7
    v_subrev_u32 v103, 65536, v31
    s_lshl_b32 s46, s3, 5
    v_add_u32 v6, s46, v3
    v_mul_u32_u24 v6, 896, v6
    v_lshl_add_u32 v10, v2, 3, v6
    v_lshlrev_b32 v11, 4, v1
    s_mov_b32 s43, 0
    s_lshl_b32 s46, s3, 12
    s_cmp_eq_u32 s3, 3
    s_cbranch_scc1 L_loader
    buffer_load_dwordx2 a[64:65], v10, s[20:23], 0 offen offset:0
    buffer_load_dwordx2 a[66:67], v10, s[20:23], 0 offen offset:16
    buffer_load_dwordx2 a[68:69], v10, s[20:23], 0 offen offset:32
    buffer_load_dwordx2 a[70:71], v10, s[20:23], 0 offen offset:48
    buffer_load_dwordx2 a[72:73], v10, s[20:23], 0 offen offset:64
    buffer_load_dwordx2 a[74:75], v10, s[20:23], 0 offen offset:80
    buffer_load_dwordx2 a[76:77], v10, s[20:23], 0 offen offset:96
    buffer_load_dwordx2 a[78:79], v10, s[20:23], 0 offen offset:112
    buffer_load_dwordx2 a[80:81], v10, s[20:23], 0 offen offset:128
    buffer_load_dwordx2 a[82:83], v10, s[20:23], 0 offen offset:144
    buffer_load_dwordx2 a[84:85], v10, s[20:23], 0 offen offset:160
    buffer_load_dwordx2 a[86:87], v10, s[20:23], 0 offen offset:176
    buffer_load_dwordx2 a[88:89], v10, s[20:23], 0 offen offset:192
    buffer_load_dwordx2 a[90:91], v10, s[20:23], 0 offen offset:208
    buffer_load_dwordx2 a[92:93], v10, s[20:23], 0 offen offset:224
    buffer_load_dwordx2 a[94:95], v10, s[20:23], 0 offen offset:240
    buffer_load_dwordx2 a[96:97], v10, s[20:23], 0 offen offset:256
    buffer_load_dwordx2 a[98:99], v10, s[20:23], 0 offen offset:272
    buffer_load_dwordx2 a[100:101], v10, s[20:23], 0 offen offset:288
    buffer_load_dwordx2 a[102:103], v10, s[20:23], 0 offen offset:304
    buffer_load_dwordx2 a[104:105], v10, s[20:23], 0 offen offset:320
    buffer_load_dwordx2 a[106:107], v10, s[20:23], 0 offen offset:336
    buffer_load_dwordx2 a[108:109], v10, s[20:23], 0 offen offset:352
    buffer_load_dwordx2 a[110:111], v10, s[20:23], 0 offen offset:368
    buffer_load_dwordx2 a[112:113], v10, s[20:23], 0 offen offset:384
    buffer_load_dwordx2 a[114:115], v10, s[20:23], 0 offen offset:400
    buffer_load_dwordx2 a[116:117], v10, s[20:23], 0 offen offset:416
    buffer_load_dwordx2 a[118:119], v10, s[20:23], 0 offen offset:432
    buffer_load_dwordx2 a[120:121], v10, s[20:23], 0 offen offset:448
    buffer_load_dwordx2 a[122:123], v10, s[20:23], 0 offen offset:464
    buffer_load_dwordx2 a[124:125], v10, s[20:23], 0 offen offset:480
    buffer_load_dwordx2 a[126:127], v10, s[20:23], 0 offen offset:496
    buffer_load_dwordx2 a[128:129], v10, s[20:23], 0 offen offset:512
    buffer_load_dwordx2 a[130:131], v10, s[20:23], 0 offen offset:528
    buffer_load_dwordx2 a[132:133], v10, s[20:23], 0 offen offset:544
    buffer_load_dwordx2 a[134:135], v10, s[20:23], 0 offen offset:560
    buffer_load_dwordx2 a[136:137], v10, s[20:23], 0 offen offset:576
    buffer_load_dwordx2 a[138:139], v10, s[20:23], 0 offen offset:592
    buffer_load_dwordx2 a[140:141], v10, s[20:23], 0 offen offset:608
    buffer_load_dwordx2 a[142:143], v10, s[20:23], 0 offen offset:624
    buffer_load_dwordx2 a[144:145], v10, s[20:23], 0 offen offset:640
    buffer_load_dwordx2 a[146:147], v10, s[20:23], 0 offen offset:656
    buffer_load_dwordx2 a[148:149], v10, s[20:23], 0 offen offset:672
    buffer_load_dwordx2 a[150:151], v10, s[20:23], 0 offen offset:688
    buffer_load_dwordx2 a[152:153], v10, s[20:23], 0 offen offset:704
    buffer_load_dwordx2 a[154:155], v10, s[20:23], 0 offen offset:720
    buffer_load_dwordx2 a[156:157], v10, s[20:23], 0 offen offset:736
    buffer_load_dwordx2 a[158:159], v10, s[20:23], 0 offen offset:752
    buffer_load_dwordx2 a[160:161], v10, s[20:23], 0 offen offset:768
    buffer_load_dwordx2 a[162:163], v10, s[20:23], 0 offen offset:784
    buffer_load_dwordx2 a[164:165], v10, s[20:23], 0 offen offset:800
    buffer_load_dwordx2 a[166:167], v10, s[20:23], 0 offen offset:816
    buffer_load_dwordx2 a[168:169], v10, s[20:23], 0 offen offset:832
    buffer_load_dwordx2 a[170:171], v10, s[20:23], 0 offen offset:848
    buffer_load_dwordx2 a[172:173], v10, s[20:23], 0 offen offset:864
    buffer_load_dwordx2 a[174:175], v10, s[20:23], 0 offen offset:880
    v_mov_b32 v128, 0
    v_mov_b32 v129, 0
    v_mov_b32 v130, 0
    v_mov_b32 v131, 0
    v_mov_b32 v132, 0
    v_mov_b32 v133, 0
    v_mov_b32 v134, 0
    v_mov_b32 v135, 0
    v_mov_b32 v136, 0
    v_mov_b32 v137, 0
    v_mov_b32 v138, 0
    v_mov_b32 v139, 0
    v_mov_b32 v140, 0
    v_mov_b32 v141, 0
    v_mov_b32 v142, 0
    v_mov_b32 v143, 0
    v_mov_b32 v144, 0
    v_mov_b32 v145, 0
    v_mov_b32 v146, 0
    v_mov_b32 v147, 0
    v_mov_b32 v148, 0
    v_mov_b32 v149, 0
    v_mov_b32 v150, 0
    v_mov_b32 v151, 0
    v_mov_b32 v152, 0
    v_mov_b32 v153, 0
    v_mov_b32 v154, 0
    v_mov_b32 v155, 0
    v_mov_b32 v156, 0
    v_mov_b32 v157, 0
    v_mov_b32 v158, 0
    v_mov_b32 v159, 0
    v_mov_b32 v160, 0
    v_mov_b32 v161, 0
    v_mov_b32 v162, 0
    v_mov_b32 v163, 0
    v_mov_b32 v164, 0
    v_mov_b32 v165, 0
    v_mov_b32 v166, 0
    v_mov_b32 v167, 0
    v_mov_b32 v168, 0
    v_mov_b32 v169, 0
    v_mov_b32 v170, 0
    v_mov_b32 v171, 0
    v_mov_b32 v172, 0
    v_mov_b32 v173, 0
    v_mov_b32 v174, 0
    v_mov_b32 v175, 0
    v_mov_b32 v176, 0
    v_mov_b32 v177, 0
    v_mov_b32 v178, 0
    v_mov_b32 v179, 0
    v_mov_b32 v180, 0
    v_mov_b32 v181, 0
    v_mov_b32 v182, 0
    v_mov_b32 v183, 0
    v_mov_b32 v184, 0
    v_mov_b32 v185, 0
    v_mov_b32 v186, 0
    v_mov_b32 v187, 0
    v_mov_b32 v188, 0
    v_mov_b32 v189, 0
    v_mov_b32 v190, 0
    v_mov_b32 v191, 0
    v_mov_b32 v192, 0
    v_mov_b32 v193, 0
    v_mov_b32 v194, 0
    v_mov_b32 v195, 0
    v_mov_b32 v196, 0
    v_mov_b32 v197, 0
    v_mov_b32 v198, 0
    v_mov_b32 v199, 0
    v_mov_b32 v200, 0
    v_mov_b32 v201, 0
    v_mov_b32 v202, 0
    v_mov_b32 v203, 0
    v_mov_b32 v204, 0
    v_mov_b32 v205, 0
    v_mov_b32 v206, 0
    v_mov_b32 v207, 0
    v_mov_b32 v208, 0
    v_mov_b32 v209, 0
    v_mov_b32 v210, 0
    v_mov_b32 v211, 0
    v_mov_b32 v212, 0
    v_mov_b32 v213, 0
    v_mov_b32 v214, 0
    v_mov_b32 v215, 0
    v_mov_b32 v216, 0
    v_mov_b32 v217, 0
    v_mov_b32 v218, 0
    v_mov_b32 v219, 0
    v_mov_b32 v220, 0
    v_mov_b32 v221, 0
    v_mov_b32 v222, 0
    v_mov_b32 v223, 0
    v_mov_b32 v224, 0
    v_mov_b32 v225, 0
    v_mov_b32 v226, 0
    v_mov_b32 v227, 0
    v_mov_b32 v228, 0
    v_mov_b32 v229, 0
    v_mov_b32 v230, 0
    v_mov_b32 v231, 0
    v_mov_b32 v232, 0
    v_mov_b32 v233, 0
    v_mov_b32 v234, 0
    v_mov_b32 v235, 0
    v_mov_b32 v236, 0
    v_mov_b32 v237, 0
    v_mov_b32 v238, 0
    v_mov_b32 v239, 0
    v_mov_b32 v240, 0
    v_mov_b32 v241, 0
    v_mov_b32 v242, 0
    v_mov_b32 v243, 0
    v_mov_b32 v244, 0
    v_mov_b32 v245, 0
    v_mov_b32 v246, 0
    v_mov_b32 v247, 0
    v_mov_b32 v248, 0
    v_mov_b32 v249, 0
    v_mov_b32 v250, 0
    v_mov_b32 v251, 0
    v_mov_b32 v252, 0
    v_mov_b32 v253, 0
    v_mov_b32 v254, 0
    v_mov_b32 v255, 0
    s_add_u32 s45, s46, 65536
    s_mov_b32 m0, s45
    s_mov_b32 s47, 0
    buffer_load_dwordx4 v18, s[8:11], s47 offen offset:0 lds
    s_mov_b32 s47, 15360
    buffer_load_dwordx4 v19, s[8:11], s47 offen offset:1024 lds
    s_mov_b32 s47, 30720
    buffer_load_dwordx4 v18, s[8:11], s47 offen offset:2048 lds
    s_mov_b32 s47, 46080
    buffer_load_dwordx4 v19, s[8:11], s47 offen offset:3072 lds
    s_add_u32 s45, s46, 81920
    s_mov_b32 m0, s45
    s_mov_b32 s47, 262144
    buffer_load_dwordx4 v18, s[8:11], s47 offen offset:0 lds
    s_mov_b32 s47, 277504
    buffer_load_dwordx4 v19, s[8:11], s47 offen offset:1024 lds
    s_mov_b32 s47, 292864
    buffer_load_dwordx4 v18, s[8:11], s47 offen offset:2048 lds
    s_mov_b32 s47, 308224
    buffer_load_dwordx4 v19, s[8:11], s47 offen offset:3072 lds
    s_add_u32 s45, s46, 98304
    s_mov_b32 m0, s45
    s_mov_b32 s47, 524288
    buffer_load_dwordx4 v18, s[8:11], s47 offen offset:0 lds
    s_mov_b32 s47, 539648
    buffer_load_dwordx4 v19, s[8:11], s47 offen offset:1024 lds
    s_mov_b32 s47, 555008
    buffer_load_dwordx4 v18, s[8:11], s47 offen offset:2048 lds
    s_mov_b32 s47, 570368
    buffer_load_dwordx4 v19, s[8:11], s47 offen offset:3072 lds
    s_add_u32 s45, s46, 114688
    s_mov_b32 m0, s45
    s_mov_b32 s47, 786432
    buffer_load_dwordx4 v18, s[8:11], s47 offen offset:0 lds
    s_mov_b32 s47, 801792
    buffer_load_dwordx4 v19, s[8:11], s47 offen offset:1024 lds
    s_mov_b32 s47, 817152
    buffer_load_dwordx4 v18, s[8:11], s47 offen offset:2048 lds
    s_mov_b32 s47, 832512
    buffer_load_dwordx4 v19, s[8:11], s47 offen offset:3072 lds
    s_add_u32 s45, s46, 0
    s_mov_b32 m0, s45
    s_mov_b32 s47, 1048576
    buffer_load_dwordx4 v18, s[8:11], s47 offen offset:0 lds
    s_mov_b32 s47, 1063936
    buffer_load_dwordx4 v19, s[8:11], s47 offen offset:1024 lds
    s_mov_b32 s47, 1079296
    buffer_load_dwordx4 v18, s[8:11], s47 offen offset:2048 lds
    s_mov_b32 s47, 1094656
    buffer_load_dwordx4 v19, s[8:11], s47 offen offset:3072 lds
    s_add_u32 s45, s46, 16384
    s_mov_b32 m0, s45
    s_mov_b32 s47, 1310720
    buffer_load_dwordx4 v18, s[8:11], s47 offen offset:0 lds
    s_mov_b32 s47, 1326080
    buffer_load_dwordx4 v19, s[8:11], s47 offen offset:1024 lds
    s_mov_b32 s47, 1341440
    buffer_load_dwordx4 v18, s[8:11], s47 offen offset:2048 lds
    s_mov_b32 s47, 1356800
    buffer_load_dwordx4 v19, s[8:11], s47 offen offset:3072 lds
    s_add_u32 s45, s46, 32768
    s_mov_b32 m0, s45
    s_mov_b32 s47, 1572864
    buffer_load_dwordx4 v18, s[8:11], s47 offen offset:0 lds
    s_mov_b32 s47, 1588224
    buffer_load_dwordx4 v19, s[8:11], s47 offen offset:1024 lds
    s_mov_b32 s47, 1603584
    buffer_load_dwordx4 v18, s[8:11], s47 offen offset:2048 lds
    s_mov_b32 s47, 1618944
    buffer_load_dwordx4 v19, s[8:11], s47 offen offset:3072 lds
    s_waitcnt vmcnt(24) lgkmcnt(0)
    s_barrier
    s_add_u32 s45, s46, 49152
    s_mov_b32 m0, s45
    s_mov_b32 s47, 1835008
    buffer_load_dwordx4 v18, s[8:11], s47 offen offset:0 lds
    s_mov_b32 s47, 1850368
    buffer_load_dwordx4 v19, s[8:11], s47 offen offset:1024 lds
    s_mov_b32 s47, 1865728
    buffer_load_dwordx4 v18, s[8:11], s47 offen offset:2048 lds
    s_mov_b32 s47, 1881088
    buffer_load_dwordx4 v19, s[8:11], s47 offen offset:3072 lds
    ds_read_b64_tr_b16 v[104:105], v28 offset:0
    ds_read_b64_tr_b16 v[106:107], v28 offset:4096
    ds_read_b64_tr_b16 v[108:109], v29 offset:0
    ds_read_b64_tr_b16 v[110:111], v29 offset:4096
    ds_read_b64_tr_b16 v[112:113], v30 offset:0
    ds_read_b64_tr_b16 v[114:115], v30 offset:4096
    ds_read_b64_tr_b16 v[116:117], v31 offset:0
    ds_read_b64_tr_b16 v[118:119], v31 offset:4096
    ds_read_b64_tr_b16 v[120:121], v28 offset:256
    ds_read_b64_tr_b16 v[122:123], v28 offset:4352
    ds_read_b64_tr_b16 v[124:125], v29 offset:256
    ds_read_b64_tr_b16 v[126:127], v29 offset:4352
    s_waitcnt lgkmcnt(10)
    v_mfma_f32_32x32x16_bf16 v[128:143], v[104:107], a[64:67], v[128:143]
    ds_read_b64_tr_b16 v[104:105], v30 offset:256
    ds_read_b64_tr_b16 v[106:107], v30 offset:4352
    s_waitcnt lgkmcnt(10)
    v_mfma_f32_32x32x16_bf16 v[144:159], v[108:111], a[64:67], v[144:159]
    ds_read_b64_tr_b16 v[108:109], v31 offset:256
    ds_read_b64_tr_b16 v[110:111], v31 offset:4352
    s_waitcnt lgkmcnt(10)
    v_mfma_f32_32x32x16_bf16 v[160:175], v[112:115], a[64:67], v[160:175]
    ds_read_b64_tr_b16 v[112:113], v28 offset:8192
    ds_read_b64_tr_b16 v[114:115], v28 offset:12288
    s_waitcnt lgkmcnt(10)
    v_mfma_f32_32x32x16_bf16 v[176:191], v[116:119], a[64:67], v[176:191]
    ds_read_b64_tr_b16 v[116:117], v29 offset:8192
    ds_read_b64_tr_b16 v[118:119], v29 offset:12288
    s_waitcnt lgkmcnt(10)
    v_mfma_f32_32x32x16_bf16 v[192:207], v[120:123], a[64:67], v[192:207]
    ds_read_b64_tr_b16 v[120:121], v30 offset:8192
    ds_read_b64_tr_b16 v[122:123], v30 offset:12288
    s_waitcnt lgkmcnt(10)
    v_mfma_f32_32x32x16_bf16 v[208:223], v[124:127], a[64:67], v[208:223]
    ds_read_b64_tr_b16 v[124:125], v31 offset:8192
    ds_read_b64_tr_b16 v[126:127], v31 offset:12288
    s_waitcnt lgkmcnt(10)
    v_mfma_f32_32x32x16_bf16 v[224:239], v[104:107], a[64:67], v[224:239]
    ds_read_b64_tr_b16 v[104:105], v28 offset:8448
    ds_read_b64_tr_b16 v[106:107], v28 offset:12544
    s_waitcnt lgkmcnt(10)
    v_mfma_f32_32x32x16_bf16 v[240:255], v[108:111], a[64:67], v[240:255]
    ds_read_b64_tr_b16 v[108:109], v29 offset:8448
    ds_read_b64_tr_b16 v[110:111], v29 offset:12544
    s_waitcnt lgkmcnt(10)
    v_mfma_f32_32x32x16_bf16 v[128:143], v[112:115], a[68:71], v[128:143]
    ds_read_b64_tr_b16 v[112:113], v30 offset:8448
    ds_read_b64_tr_b16 v[114:115], v30 offset:12544
    s_waitcnt lgkmcnt(10)
    v_mfma_f32_32x32x16_bf16 v[144:159], v[116:119], a[68:71], v[144:159]
    ds_read_b64_tr_b16 v[116:117], v31 offset:8448
    ds_read_b64_tr_b16 v[118:119], v31 offset:12544
    s_waitcnt lgkmcnt(10)
    v_mfma_f32_32x32x16_bf16 v[160:175], v[120:123], a[68:71], v[160:175]
    s_waitcnt lgkmcnt(8)
    v_mfma_f32_32x32x16_bf16 v[176:191], v[124:127], a[68:71], v[176:191]
    s_waitcnt lgkmcnt(6)
    v_mfma_f32_32x32x16_bf16 v[192:207], v[104:107], a[68:71], v[192:207]
    s_waitcnt lgkmcnt(4)
    v_mfma_f32_32x32x16_bf16 v[208:223], v[108:111], a[68:71], v[208:223]
    s_waitcnt lgkmcnt(2)
    v_mfma_f32_32x32x16_bf16 v[224:239], v[112:115], a[68:71], v[224:239]
    s_waitcnt lgkmcnt(0)
    v_mfma_f32_32x32x16_bf16 v[240:255], v[116:119], a[68:71], v[240:255]
    s_waitcnt vmcnt(24) lgkmcnt(0)
    s_barrier
    s_add_u32 s45, s46, 65536
    s_mov_b32 m0, s45
    s_mov_b32 s47, 2097152
    buffer_load_dwordx4 v18, s[8:11], s47 offen offset:0 lds
    s_mov_b32 s47, 2112512
    buffer_load_dwordx4 v19, s[8:11], s47 offen offset:1024 lds
    s_mov_b32 s47, 2127872
    buffer_load_dwordx4 v18, s[8:11], s47 offen offset:2048 lds
    s_mov_b32 s47, 2143232
    buffer_load_dwordx4 v19, s[8:11], s47 offen offset:3072 lds
    ds_read_b64_tr_b16 v[104:105], v28 offset:16384
    ds_read_b64_tr_b16 v[106:107], v28 offset:20480
    ds_read_b64_tr_b16 v[108:109], v29 offset:16384
    ds_read_b64_tr_b16 v[110:111], v29 offset:20480
    ds_read_b64_tr_b16 v[112:113], v30 offset:16384
    ds_read_b64_tr_b16 v[114:115], v30 offset:20480
    ds_read_b64_tr_b16 v[116:117], v31 offset:16384
    ds_read_b64_tr_b16 v[118:119], v31 offset:20480
    ds_read_b64_tr_b16 v[120:121], v28 offset:16640
    ds_read_b64_tr_b16 v[122:123], v28 offset:20736
    ds_read_b64_tr_b16 v[124:125], v29 offset:16640
    ds_read_b64_tr_b16 v[126:127], v29 offset:20736
    s_waitcnt lgkmcnt(10)
    v_mfma_f32_32x32x16_bf16 v[128:143], v[104:107], a[72:75], v[128:143]
    ds_read_b64_tr_b16 v[104:105], v30 offset:16640
    ds_read_b64_tr_b16 v[106:107], v30 offset:20736
    s_waitcnt lgkmcnt(10)
    v_mfma_f32_32x32x16_bf16 v[144:159], v[108:111], a[72:75], v[144:159]
    ds_read_b64_tr_b16 v[108:109], v31 offset:16640
    ds_read_b64_tr_b16 v[110:111], v31 offset:20736
    s_waitcnt lgkmcnt(10)
    v_mfma_f32_32x32x16_bf16 v[160:175], v[112:115], a[72:75], v[160:175]
    ds_read_b64_tr_b16 v[112:113], v28 offset:24576
    ds_read_b64_tr_b16 v[114:115], v28 offset:28672
    s_waitcnt lgkmcnt(10)
    v_mfma_f32_32x32x16_bf16 v[176:191], v[116:119], a[72:75], v[176:191]
    ds_read_b64_tr_b16 v[116:117], v29 offset:24576
    ds_read_b64_tr_b16 v[118:119], v29 offset:28672
    s_waitcnt lgkmcnt(10)
    v_mfma_f32_32x32x16_bf16 v[192:207], v[120:123], a[72:75], v[192:207]
    ds_read_b64_tr_b16 v[120:121], v30 offset:24576
    ds_read_b64_tr_b16 v[122:123], v30 offset:28672
    s_waitcnt lgkmcnt(10)
    v_mfma_f32_32x32x16_bf16 v[208:223], v[124:127], a[72:75], v[208:223]
    ds_read_b64_tr_b16 v[124:125], v31 offset:24576
    ds_read_b64_tr_b16 v[126:127], v31 offset:28672
    s_waitcnt lgkmcnt(10)
    v_mfma_f32_32x32x16_bf16 v[224:239], v[104:107], a[72:75], v[224:239]
    ds_read_b64_tr_b16 v[104:105], v28 offset:24832
    ds_read_b64_tr_b16 v[106:107], v28 offset:28928
    s_waitcnt lgkmcnt(10)
    v_mfma_f32_32x32x16_bf16 v[240:255], v[108:111], a[72:75], v[240:255]
    ds_read_b64_tr_b16 v[108:109], v29 offset:24832
    ds_read_b64_tr_b16 v[110:111], v29 offset:28928
    s_waitcnt lgkmcnt(10)
    v_mfma_f32_32x32x16_bf16 v[128:143], v[112:115], a[76:79], v[128:143]
    ds_read_b64_tr_b16 v[112:113], v30 offset:24832
    ds_read_b64_tr_b16 v[114:115], v30 offset:28928
    s_waitcnt lgkmcnt(10)
    v_mfma_f32_32x32x16_bf16 v[144:159], v[116:119], a[76:79], v[144:159]
    ds_read_b64_tr_b16 v[116:117], v31 offset:24832
    ds_read_b64_tr_b16 v[118:119], v31 offset:28928
    s_waitcnt lgkmcnt(10)
    v_mfma_f32_32x32x16_bf16 v[160:175], v[120:123], a[76:79], v[160:175]
    s_waitcnt lgkmcnt(8)
    v_mfma_f32_32x32x16_bf16 v[176:191], v[124:127], a[76:79], v[176:191]
    s_waitcnt lgkmcnt(6)
    v_mfma_f32_32x32x16_bf16 v[192:207], v[104:107], a[76:79], v[192:207]
    s_waitcnt lgkmcnt(4)
    v_mfma_f32_32x32x16_bf16 v[208:223], v[108:111], a[76:79], v[208:223]
    s_waitcnt lgkmcnt(2)
    v_mfma_f32_32x32x16_bf16 v[224:239], v[112:115], a[76:79], v[224:239]
    s_waitcnt lgkmcnt(0)
    v_mfma_f32_32x32x16_bf16 v[240:255], v[116:119], a[76:79], v[240:255]
    s_waitcnt vmcnt(24) lgkmcnt(0)
    s_barrier
    s_add_u32 s45, s46, 81920
    s_mov_b32 m0, s45
    s_mov_b32 s47, 2359296
    buffer_load_dwordx4 v18, s[8:11], s47 offen offset:0 lds
    s_mov_b32 s47, 2374656
    buffer_load_dwordx4 v19, s[8:11], s47 offen offset:1024 lds
    s_mov_b32 s47, 2390016
    buffer_load_dwordx4 v18, s[8:11], s47 offen offset:2048 lds
    s_mov_b32 s47, 2405376
    buffer_load_dwordx4 v19, s[8:11], s47 offen offset:3072 lds
    ds_read_b64_tr_b16 v[104:105], v28 offset:32768
    ds_read_b64_tr_b16 v[106:107], v28 offset:36864
    ds_read_b64_tr_b16 v[108:109], v29 offset:32768
    ds_read_b64_tr_b16 v[110:111], v29 offset:36864
    ds_read_b64_tr_b16 v[112:113], v30 offset:32768
    ds_read_b64_tr_b16 v[114:115], v30 offset:36864
    ds_read_b64_tr_b16 v[116:117], v31 offset:32768
    ds_read_b64_tr_b16 v[118:119], v31 offset:36864
    ds_read_b64_tr_b16 v[120:121], v28 offset:33024
    ds_read_b64_tr_b16 v[122:123], v28 offset:37120
    ds_read_b64_tr_b16 v[124:125], v29 offset:33024
    ds_read_b64_tr_b16 v[126:127], v29 offset:37120
    s_waitcnt lgkmcnt(10)
    v_mfma_f32_32x32x16_bf16 v[128:143], v[104:107], a[80:83], v[128:143]
    ds_read_b64_tr_b16 v[104:105], v30 offset:33024
    ds_read_b64_tr_b16 v[106:107], v30 offset:37120
    s_waitcnt lgkmcnt(10)
    v_mfma_f32_32x32x16_bf16 v[144:159], v[108:111], a[80:83], v[144:159]
    ds_read_b64_tr_b16 v[108:109], v31 offset:33024
    ds_read_b64_tr_b16 v[110:111], v31 offset:37120
    s_waitcnt lgkmcnt(10)
    v_mfma_f32_32x32x16_bf16 v[160:175], v[112:115], a[80:83], v[160:175]
    ds_read_b64_tr_b16 v[112:113], v28 offset:40960
    ds_read_b64_tr_b16 v[114:115], v28 offset:45056
    s_waitcnt lgkmcnt(10)
    v_mfma_f32_32x32x16_bf16 v[176:191], v[116:119], a[80:83], v[176:191]
    ds_read_b64_tr_b16 v[116:117], v29 offset:40960
    ds_read_b64_tr_b16 v[118:119], v29 offset:45056
    s_waitcnt lgkmcnt(10)
    v_mfma_f32_32x32x16_bf16 v[192:207], v[120:123], a[80:83], v[192:207]
    ds_read_b64_tr_b16 v[120:121], v30 offset:40960
    ds_read_b64_tr_b16 v[122:123], v30 offset:45056
    s_waitcnt lgkmcnt(10)
    v_mfma_f32_32x32x16_bf16 v[208:223], v[124:127], a[80:83], v[208:223]
    ds_read_b64_tr_b16 v[124:125], v31 offset:40960
    ds_read_b64_tr_b16 v[126:127], v31 offset:45056
    s_waitcnt lgkmcnt(10)
    v_mfma_f32_32x32x16_bf16 v[224:239], v[104:107], a[80:83], v[224:239]
    ds_read_b64_tr_b16 v[104:105], v28 offset:41216
    ds_read_b64_tr_b16 v[106:107], v28 offset:45312
    s_waitcnt lgkmcnt(10)
    v_mfma_f32_32x32x16_bf16 v[240:255], v[108:111], a[80:83], v[240:255]
    ds_read_b64_tr_b16 v[108:109], v29 offset:41216
    ds_read_b64_tr_b16 v[110:111], v29 offset:45312
    s_waitcnt lgkmcnt(10)
    v_mfma_f32_32x32x16_bf16 v[128:143], v[112:115], a[84:87], v[128:143]
    ds_read_b64_tr_b16 v[112:113], v30 offset:41216
    ds_read_b64_tr_b16 v[114:115], v30 offset:45312
    s_waitcnt lgkmcnt(10)
    v_mfma_f32_32x32x16_bf16 v[144:159], v[116:119], a[84:87], v[144:159]
    ds_read_b64_tr_b16 v[116:117], v31 offset:41216
    ds_read_b64_tr_b16 v[118:119], v31 offset:45312
    s_waitcnt lgkmcnt(10)
    v_mfma_f32_32x32x16_bf16 v[160:175], v[120:123], a[84:87], v[160:175]
    s_waitcnt lgkmcnt(8)
    v_mfma_f32_32x32x16_bf16 v[176:191], v[124:127], a[84:87], v[176:191]
    s_waitcnt lgkmcnt(6)
    v_mfma_f32_32x32x16_bf16 v[192:207], v[104:107], a[84:87], v[192:207]
    s_waitcnt lgkmcnt(4)
    v_mfma_f32_32x32x16_bf16 v[208:223], v[108:111], a[84:87], v[208:223]
    s_waitcnt lgkmcnt(2)
    v_mfma_f32_32x32x16_bf16 v[224:239], v[112:115], a[84:87], v[224:239]
    s_waitcnt lgkmcnt(0)
    v_mfma_f32_32x32x16_bf16 v[240:255], v[116:119], a[84:87], v[240:255]
    s_waitcnt vmcnt(24) lgkmcnt(0)
    s_barrier
    s_add_u32 s45, s46, 98304
    s_mov_b32 m0, s45
    s_mov_b32 s47, 2621440
    buffer_load_dwordx4 v18, s[8:11], s47 offen offset:0 lds
    s_mov_b32 s47, 2636800
    buffer_load_dwordx4 v19, s[8:11], s47 offen offset:1024 lds
    s_mov_b32 s47, 2652160
    buffer_load_dwordx4 v18, s[8:11], s47 offen offset:2048 lds
    s_mov_b32 s47, 2667520
    buffer_load_dwordx4 v19, s[8:11], s47 offen offset:3072 lds
    ds_read_b64_tr_b16 v[104:105], v28 offset:49152
    ds_read_b64_tr_b16 v[106:107], v28 offset:53248
    ds_read_b64_tr_b16 v[108:109], v29 offset:49152
    ds_read_b64_tr_b16 v[110:111], v29 offset:53248
    ds_read_b64_tr_b16 v[112:113], v30 offset:49152
    ds_read_b64_tr_b16 v[114:115], v30 offset:53248
    ds_read_b64_tr_b16 v[116:117], v31 offset:49152
    ds_read_b64_tr_b16 v[118:119], v31 offset:53248
    ds_read_b64_tr_b16 v[120:121], v28 offset:49408
    ds_read_b64_tr_b16 v[122:123], v28 offset:53504
    ds_read_b64_tr_b16 v[124:125], v29 offset:49408
    ds_read_b64_tr_b16 v[126:127], v29 offset:53504
    s_waitcnt lgkmcnt(10)
    v_mfma_f32_32x32x16_bf16 v[128:143], v[104:107], a[88:91], v[128:143]
    ds_read_b64_tr_b16 v[104:105], v30 offset:49408
    ds_read_b64_tr_b16 v[106:107], v30 offset:53504
    s_waitcnt lgkmcnt(10)
    v_mfma_f32_32x32x16_bf16 v[144:159], v[108:111], a[88:91], v[144:159]
    ds_read_b64_tr_b16 v[108:109], v31 offset:49408
    ds_read_b64_tr_b16 v[110:111], v31 offset:53504
    s_waitcnt lgkmcnt(10)
    v_mfma_f32_32x32x16_bf16 v[160:175], v[112:115], a[88:91], v[160:175]
    ds_read_b64_tr_b16 v[112:113], v28 offset:57344
    ds_read_b64_tr_b16 v[114:115], v28 offset:61440
    s_waitcnt lgkmcnt(10)
    v_mfma_f32_32x32x16_bf16 v[176:191], v[116:119], a[88:91], v[176:191]
    ds_read_b64_tr_b16 v[116:117], v29 offset:57344
    ds_read_b64_tr_b16 v[118:119], v29 offset:61440
    s_waitcnt lgkmcnt(10)
    v_mfma_f32_32x32x16_bf16 v[192:207], v[120:123], a[88:91], v[192:207]
    ds_read_b64_tr_b16 v[120:121], v30 offset:57344
    ds_read_b64_tr_b16 v[122:123], v30 offset:61440
    s_waitcnt lgkmcnt(10)
    v_mfma_f32_32x32x16_bf16 v[208:223], v[124:127], a[88:91], v[208:223]
    ds_read_b64_tr_b16 v[124:125], v31 offset:57344
    ds_read_b64_tr_b16 v[126:127], v31 offset:61440
    s_waitcnt lgkmcnt(10)
    v_mfma_f32_32x32x16_bf16 v[224:239], v[104:107], a[88:91], v[224:239]
    ds_read_b64_tr_b16 v[104:105], v28 offset:57600
    ds_read_b64_tr_b16 v[106:107], v28 offset:61696
    s_waitcnt lgkmcnt(10)
    v_mfma_f32_32x32x16_bf16 v[240:255], v[108:111], a[88:91], v[240:255]
    ds_read_b64_tr_b16 v[108:109], v29 offset:57600
    ds_read_b64_tr_b16 v[110:111], v29 offset:61696
    s_waitcnt lgkmcnt(10)
    v_mfma_f32_32x32x16_bf16 v[128:143], v[112:115], a[92:95], v[128:143]
    ds_read_b64_tr_b16 v[112:113], v30 offset:57600
    ds_read_b64_tr_b16 v[114:115], v30 offset:61696
    s_waitcnt lgkmcnt(10)
    v_mfma_f32_32x32x16_bf16 v[144:159], v[116:119], a[92:95], v[144:159]
    ds_read_b64_tr_b16 v[116:117], v31 offset:57600
    ds_read_b64_tr_b16 v[118:119], v31 offset:61696
    s_waitcnt lgkmcnt(10)
    v_mfma_f32_32x32x16_bf16 v[160:175], v[120:123], a[92:95], v[160:175]
    s_waitcnt lgkmcnt(8)
    v_mfma_f32_32x32x16_bf16 v[176:191], v[124:127], a[92:95], v[176:191]
    s_waitcnt lgkmcnt(6)
    v_mfma_f32_32x32x16_bf16 v[192:207], v[104:107], a[92:95], v[192:207]
    s_waitcnt lgkmcnt(4)
    v_mfma_f32_32x32x16_bf16 v[208:223], v[108:111], a[92:95], v[208:223]
    s_waitcnt lgkmcnt(2)
    v_mfma_f32_32x32x16_bf16 v[224:239], v[112:115], a[92:95], v[224:239]
    s_waitcnt lgkmcnt(0)
    v_mfma_f32_32x32x16_bf16 v[240:255], v[116:119], a[92:95], v[240:255]
    s_waitcnt vmcnt(24) lgkmcnt(0)
    s_barrier
    s_add_u32 s45, s46, 114688
    s_mov_b32 m0, s45
    s_mov_b32 s47, 2883584
    buffer_load_dwordx4 v18, s[8:11], s47 offen offset:0 lds
    s_mov_b32 s47, 2898944
    buffer_load_dwordx4 v19, s[8:11], s47 offen offset:1024 lds
    s_mov_b32 s47, 2914304
    buffer_load_dwordx4 v18, s[8:11], s47 offen offset:2048 lds
    s_mov_b32 s47, 2929664
    buffer_load_dwordx4 v19, s[8:11], s47 offen offset:3072 lds
    ds_read_b64_tr_b16 v[104:105], v100 offset:0
    ds_read_b64_tr_b16 v[106:107], v100 offset:4096
    ds_read_b64_tr_b16 v[108:109], v101 offset:0
    ds_read_b64_tr_b16 v[110:111], v101 offset:4096
    ds_read_b64_tr_b16 v[112:113], v102 offset:0
    ds_read_b64_tr_b16 v[114:115], v102 offset:4096
    ds_read_b64_tr_b16 v[116:117], v103 offset:0
    ds_read_b64_tr_b16 v[118:119], v103 offset:4096
    ds_read_b64_tr_b16 v[120:121], v100 offset:256
    ds_read_b64_tr_b16 v[122:123], v100 offset:4352
    ds_read_b64_tr_b16 v[124:125], v101 offset:256
    ds_read_b64_tr_b16 v[126:127], v101 offset:4352
    s_waitcnt lgkmcnt(10)
    v_mfma_f32_32x32x16_bf16 v[128:143], v[104:107], a[96:99], v[128:143]
    ds_read_b64_tr_b16 v[104:105], v102 offset:256
    ds_read_b64_tr_b16 v[106:107], v102 offset:4352
    s_waitcnt lgkmcnt(10)
    v_mfma_f32_32x32x16_bf16 v[144:159], v[108:111], a[96:99], v[144:159]
    ds_read_b64_tr_b16 v[108:109], v103 offset:256
    ds_read_b64_tr_b16 v[110:111], v103 offset:4352
    s_waitcnt lgkmcnt(10)
    v_mfma_f32_32x32x16_bf16 v[160:175], v[112:115], a[96:99], v[160:175]
    ds_read_b64_tr_b16 v[112:113], v100 offset:8192
    ds_read_b64_tr_b16 v[114:115], v100 offset:12288
    s_waitcnt lgkmcnt(10)
    v_mfma_f32_32x32x16_bf16 v[176:191], v[116:119], a[96:99], v[176:191]
    ds_read_b64_tr_b16 v[116:117], v101 offset:8192
    ds_read_b64_tr_b16 v[118:119], v101 offset:12288
    s_waitcnt lgkmcnt(10)
    v_mfma_f32_32x32x16_bf16 v[192:207], v[120:123], a[96:99], v[192:207]
    ds_read_b64_tr_b16 v[120:121], v102 offset:8192
    ds_read_b64_tr_b16 v[122:123], v102 offset:12288
    s_waitcnt lgkmcnt(10)
    v_mfma_f32_32x32x16_bf16 v[208:223], v[124:127], a[96:99], v[208:223]
    ds_read_b64_tr_b16 v[124:125], v103 offset:8192
    ds_read_b64_tr_b16 v[126:127], v103 offset:12288
    s_waitcnt lgkmcnt(10)
    v_mfma_f32_32x32x16_bf16 v[224:239], v[104:107], a[96:99], v[224:239]
    ds_read_b64_tr_b16 v[104:105], v100 offset:8448
    ds_read_b64_tr_b16 v[106:107], v100 offset:12544
    s_waitcnt lgkmcnt(10)
    v_mfma_f32_32x32x16_bf16 v[240:255], v[108:111], a[96:99], v[240:255]
    ds_read_b64_tr_b16 v[108:109], v101 offset:8448
    ds_read_b64_tr_b16 v[110:111], v101 offset:12544
    s_waitcnt lgkmcnt(10)
    v_mfma_f32_32x32x16_bf16 v[128:143], v[112:115], a[100:103], v[128:143]
    ds_read_b64_tr_b16 v[112:113], v102 offset:8448
    ds_read_b64_tr_b16 v[114:115], v102 offset:12544
    s_waitcnt lgkmcnt(10)
    v_mfma_f32_32x32x16_bf16 v[144:159], v[116:119], a[100:103], v[144:159]
    ds_read_b64_tr_b16 v[116:117], v103 offset:8448
    ds_read_b64_tr_b16 v[118:119], v103 offset:12544
    s_waitcnt lgkmcnt(10)
    v_mfma_f32_32x32x16_bf16 v[160:175], v[120:123], a[100:103], v[160:175]
    s_waitcnt lgkmcnt(8)
    v_mfma_f32_32x32x16_bf16 v[176:191], v[124:127], a[100:103], v[176:191]
    s_waitcnt lgkmcnt(6)
    v_mfma_f32_32x32x16_bf16 v[192:207], v[104:107], a[100:103], v[192:207]
    s_waitcnt lgkmcnt(4)
    v_mfma_f32_32x32x16_bf16 v[208:223], v[108:111], a[100:103], v[208:223]
    s_waitcnt lgkmcnt(2)
    v_mfma_f32_32x32x16_bf16 v[224:239], v[112:115], a[100:103], v[224:239]
    s_waitcnt lgkmcnt(0)
    v_mfma_f32_32x32x16_bf16 v[240:255], v[116:119], a[100:103], v[240:255]
    s_waitcnt vmcnt(24) lgkmcnt(0)
    s_barrier
    s_add_u32 s45, s46, 0
    s_mov_b32 m0, s45
    s_mov_b32 s47, 3145728
    buffer_load_dwordx4 v18, s[8:11], s47 offen offset:0 lds
    s_mov_b32 s47, 3161088
    buffer_load_dwordx4 v19, s[8:11], s47 offen offset:1024 lds
    s_mov_b32 s47, 3176448
    buffer_load_dwordx4 v18, s[8:11], s47 offen offset:2048 lds
    s_mov_b32 s47, 3191808
    buffer_load_dwordx4 v19, s[8:11], s47 offen offset:3072 lds
    ds_read_b64_tr_b16 v[104:105], v100 offset:16384
    ds_read_b64_tr_b16 v[106:107], v100 offset:20480
    ds_read_b64_tr_b16 v[108:109], v101 offset:16384
    ds_read_b64_tr_b16 v[110:111], v101 offset:20480
    ds_read_b64_tr_b16 v[112:113], v102 offset:16384
    ds_read_b64_tr_b16 v[114:115], v102 offset:20480
    ds_read_b64_tr_b16 v[116:117], v103 offset:16384
    ds_read_b64_tr_b16 v[118:119], v103 offset:20480
    ds_read_b64_tr_b16 v[120:121], v100 offset:16640
    ds_read_b64_tr_b16 v[122:123], v100 offset:20736
    ds_read_b64_tr_b16 v[124:125], v101 offset:16640
    ds_read_b64_tr_b16 v[126:127], v101 offset:20736
    s_waitcnt lgkmcnt(10)
    v_mfma_f32_32x32x16_bf16 v[128:143], v[104:107], a[104:107], v[128:143]
    ds_read_b64_tr_b16 v[104:105], v102 offset:16640
    ds_read_b64_tr_b16 v[106:107], v102 offset:20736
    s_waitcnt lgkmcnt(10)
    v_mfma_f32_32x32x16_bf16 v[144:159], v[108:111], a[104:107], v[144:159]
    ds_read_b64_tr_b16 v[108:109], v103 offset:16640
    ds_read_b64_tr_b16 v[110:111], v103 offset:20736
    s_waitcnt lgkmcnt(10)
    v_mfma_f32_32x32x16_bf16 v[160:175], v[112:115], a[104:107], v[160:175]
    ds_read_b64_tr_b16 v[112:113], v100 offset:24576
    ds_read_b64_tr_b16 v[114:115], v100 offset:28672
    s_waitcnt lgkmcnt(10)
    v_mfma_f32_32x32x16_bf16 v[176:191], v[116:119], a[104:107], v[176:191]
    ds_read_b64_tr_b16 v[116:117], v101 offset:24576
    ds_read_b64_tr_b16 v[118:119], v101 offset:28672
    s_waitcnt lgkmcnt(10)
    v_mfma_f32_32x32x16_bf16 v[192:207], v[120:123], a[104:107], v[192:207]
    ds_read_b64_tr_b16 v[120:121], v102 offset:24576
    ds_read_b64_tr_b16 v[122:123], v102 offset:28672
    s_waitcnt lgkmcnt(10)
    v_mfma_f32_32x32x16_bf16 v[208:223], v[124:127], a[104:107], v[208:223]
    ds_read_b64_tr_b16 v[124:125], v103 offset:24576
    ds_read_b64_tr_b16 v[126:127], v103 offset:28672
    s_waitcnt lgkmcnt(10)
    v_mfma_f32_32x32x16_bf16 v[224:239], v[104:107], a[104:107], v[224:239]
    ds_read_b64_tr_b16 v[104:105], v100 offset:24832
    ds_read_b64_tr_b16 v[106:107], v100 offset:28928
    s_waitcnt lgkmcnt(10)
    v_mfma_f32_32x32x16_bf16 v[240:255], v[108:111], a[104:107], v[240:255]
    ds_read_b64_tr_b16 v[108:109], v101 offset:24832
    ds_read_b64_tr_b16 v[110:111], v101 offset:28928
    s_waitcnt lgkmcnt(10)
    v_mfma_f32_32x32x16_bf16 v[128:143], v[112:115], a[108:111], v[128:143]
    ds_read_b64_tr_b16 v[112:113], v102 offset:24832
    ds_read_b64_tr_b16 v[114:115], v102 offset:28928
    s_waitcnt lgkmcnt(10)
    v_mfma_f32_32x32x16_bf16 v[144:159], v[116:119], a[108:111], v[144:159]
    ds_read_b64_tr_b16 v[116:117], v103 offset:24832
    ds_read_b64_tr_b16 v[118:119], v103 offset:28928
    s_waitcnt lgkmcnt(10)
    v_mfma_f32_32x32x16_bf16 v[160:175], v[120:123], a[108:111], v[160:175]
    s_waitcnt lgkmcnt(8)
    v_mfma_f32_32x32x16_bf16 v[176:191], v[124:127], a[108:111], v[176:191]
    s_waitcnt lgkmcnt(6)
    v_mfma_f32_32x32x16_bf16 v[192:207], v[104:107], a[108:111], v[192:207]
    s_waitcnt lgkmcnt(4)
    v_mfma_f32_32x32x16_bf16 v[208:223], v[108:111], a[108:111], v[208:223]
    s_waitcnt lgkmcnt(2)
    v_mfma_f32_32x32x16_bf16 v[224:239], v[112:115], a[108:111], v[224:239]
    s_waitcnt lgkmcnt(0)
    v_mfma_f32_32x32x16_bf16 v[240:255], v[116:119], a[108:111], v[240:255]
    s_waitcnt vmcnt(24) lgkmcnt(0)
    s_barrier
    s_add_u32 s45, s46, 16384
    s_mov_b32 m0, s45
    s_mov_b32 s47, 3407872
    buffer_load_dwordx4 v18, s[8:11], s47 offen offset:0 lds
    s_mov_b32 s47, 3423232
    buffer_load_dwordx4 v19, s[8:11], s47 offen offset:1024 lds
    s_mov_b32 s47, 3438592
    buffer_load_dwordx4 v18, s[8:11], s47 offen offset:2048 lds
    s_mov_b32 s47, 3453952
    buffer_load_dwordx4 v19, s[8:11], s47 offen offset:3072 lds
    ds_read_b64_tr_b16 v[104:105], v100 offset:32768
    ds_read_b64_tr_b16 v[106:107], v100 offset:36864
    ds_read_b64_tr_b16 v[108:109], v101 offset:32768
    ds_read_b64_tr_b16 v[110:111], v101 offset:36864
    ds_read_b64_tr_b16 v[112:113], v102 offset:32768
    ds_read_b64_tr_b16 v[114:115], v102 offset:36864
    ds_read_b64_tr_b16 v[116:117], v103 offset:32768
    ds_read_b64_tr_b16 v[118:119], v103 offset:36864
    ds_read_b64_tr_b16 v[120:121], v100 offset:33024
    ds_read_b64_tr_b16 v[122:123], v100 offset:37120
    ds_read_b64_tr_b16 v[124:125], v101 offset:33024
    ds_read_b64_tr_b16 v[126:127], v101 offset:37120
    s_waitcnt lgkmcnt(10)
    v_mfma_f32_32x32x16_bf16 v[128:143], v[104:107], a[112:115], v[128:143]
    ds_read_b64_tr_b16 v[104:105], v102 offset:33024
    ds_read_b64_tr_b16 v[106:107], v102 offset:37120
    s_waitcnt lgkmcnt(10)
    v_mfma_f32_32x32x16_bf16 v[144:159], v[108:111], a[112:115], v[144:159]
    ds_read_b64_tr_b16 v[108:109], v103 offset:33024
    ds_read_b64_tr_b16 v[110:111], v103 offset:37120
    s_waitcnt lgkmcnt(10)
    v_mfma_f32_32x32x16_bf16 v[160:175], v[112:115], a[112:115], v[160:175]
    ds_read_b64_tr_b16 v[112:113], v100 offset:40960
    ds_read_b64_tr_b16 v[114:115], v100 offset:45056
    s_waitcnt lgkmcnt(10)
    v_mfma_f32_32x32x16_bf16 v[176:191], v[116:119], a[112:115], v[176:191]
    ds_read_b64_tr_b16 v[116:117], v101 offset:40960
    ds_read_b64_tr_b16 v[118:119], v101 offset:45056
    s_waitcnt lgkmcnt(10)
    v_mfma_f32_32x32x16_bf16 v[192:207], v[120:123], a[112:115], v[192:207]
    ds_read_b64_tr_b16 v[120:121], v102 offset:40960
    ds_read_b64_tr_b16 v[122:123], v102 offset:45056
    s_waitcnt lgkmcnt(10)
    v_mfma_f32_32x32x16_bf16 v[208:223], v[124:127], a[112:115], v[208:223]
    ds_read_b64_tr_b16 v[124:125], v103 offset:40960
    ds_read_b64_tr_b16 v[126:127], v103 offset:45056
    s_waitcnt lgkmcnt(10)
    v_mfma_f32_32x32x16_bf16 v[224:239], v[104:107], a[112:115], v[224:239]
    ds_read_b64_tr_b16 v[104:105], v100 offset:41216
    ds_read_b64_tr_b16 v[106:107], v100 offset:45312
    s_waitcnt lgkmcnt(10)
    v_mfma_f32_32x32x16_bf16 v[240:255], v[108:111], a[112:115], v[240:255]
    ds_read_b64_tr_b16 v[108:109], v101 offset:41216
    ds_read_b64_tr_b16 v[110:111], v101 offset:45312
    s_waitcnt lgkmcnt(10)
    v_mfma_f32_32x32x16_bf16 v[128:143], v[112:115], a[116:119], v[128:143]
    ds_read_b64_tr_b16 v[112:113], v102 offset:41216
    ds_read_b64_tr_b16 v[114:115], v102 offset:45312
    s_waitcnt lgkmcnt(10)
    v_mfma_f32_32x32x16_bf16 v[144:159], v[116:119], a[116:119], v[144:159]
    ds_read_b64_tr_b16 v[116:117], v103 offset:41216
    ds_read_b64_tr_b16 v[118:119], v103 offset:45312
    s_waitcnt lgkmcnt(10)
    v_mfma_f32_32x32x16_bf16 v[160:175], v[120:123], a[116:119], v[160:175]
    s_waitcnt lgkmcnt(8)
    v_mfma_f32_32x32x16_bf16 v[176:191], v[124:127], a[116:119], v[176:191]
    s_waitcnt lgkmcnt(6)
    v_mfma_f32_32x32x16_bf16 v[192:207], v[104:107], a[116:119], v[192:207]
    s_waitcnt lgkmcnt(4)
    v_mfma_f32_32x32x16_bf16 v[208:223], v[108:111], a[116:119], v[208:223]
    s_waitcnt lgkmcnt(2)
    v_mfma_f32_32x32x16_bf16 v[224:239], v[112:115], a[116:119], v[224:239]
    s_waitcnt lgkmcnt(0)
    v_mfma_f32_32x32x16_bf16 v[240:255], v[116:119], a[116:119], v[240:255]
    s_waitcnt vmcnt(24) lgkmcnt(0)
    s_barrier
    ds_read_b64_tr_b16 v[104:105], v100 offset:49152
    ds_read_b64_tr_b16 v[106:107], v100 offset:53248
    ds_read_b64_tr_b16 v[108:109], v101 offset:49152
    ds_read_b64_tr_b16 v[110:111], v101 offset:53248
    ds_read_b64_tr_b16 v[112:113], v102 offset:49152
    ds_read_b64_tr_b16 v[114:115], v102 offset:53248
    ds_read_b64_tr_b16 v[116:117], v103 offset:49152
    ds_read_b64_tr_b16 v[118:119], v103 offset:53248
    ds_read_b64_tr_b16 v[120:121], v100 offset:49408
    ds_read_b64_tr_b16 v[122:123], v100 offset:53504
    ds_read_b64_tr_b16 v[124:125], v101 offset:49408
    ds_read_b64_tr_b16 v[126:127], v101 offset:53504
    s_waitcnt lgkmcnt(10)
    v_mfma_f32_32x32x16_bf16 v[128:143], v[104:107], a[120:123], v[128:143]
    ds_read_b64_tr_b16 v[104:105], v102 offset:49408
    ds_read_b64_tr_b16 v[106:107], v102 offset:53504
    s_waitcnt lgkmcnt(10)
    v_mfma_f32_32x32x16_bf16 v[144:159], v[108:111], a[120:123], v[144:159]
    ds_read_b64_tr_b16 v[108:109], v103 offset:49408
    ds_read_b64_tr_b16 v[110:111], v103 offset:53504
    s_waitcnt lgkmcnt(10)
    v_mfma_f32_32x32x16_bf16 v[160:175], v[112:115], a[120:123], v[160:175]
    ds_read_b64_tr_b16 v[112:113], v100 offset:57344
    ds_read_b64_tr_b16 v[114:115], v100 offset:61440
    s_waitcnt lgkmcnt(10)
    v_mfma_f32_32x32x16_bf16 v[176:191], v[116:119], a[120:123], v[176:191]
    ds_read_b64_tr_b16 v[116:117], v101 offset:57344
    ds_read_b64_tr_b16 v[118:119], v101 offset:61440
    s_waitcnt lgkmcnt(10)
    v_mfma_f32_32x32x16_bf16 v[192:207], v[120:123], a[120:123], v[192:207]
    ds_read_b64_tr_b16 v[120:121], v102 offset:57344
    ds_read_b64_tr_b16 v[122:123], v102 offset:61440
    s_waitcnt lgkmcnt(10)
    v_mfma_f32_32x32x16_bf16 v[208:223], v[124:127], a[120:123], v[208:223]
    ds_read_b64_tr_b16 v[124:125], v103 offset:57344
    ds_read_b64_tr_b16 v[126:127], v103 offset:61440
    s_waitcnt lgkmcnt(10)
    v_mfma_f32_32x32x16_bf16 v[224:239], v[104:107], a[120:123], v[224:239]
    ds_read_b64_tr_b16 v[104:105], v100 offset:57600
    ds_read_b64_tr_b16 v[106:107], v100 offset:61696
    s_waitcnt lgkmcnt(10)
    v_mfma_f32_32x32x16_bf16 v[240:255], v[108:111], a[120:123], v[240:255]
    ds_read_b64_tr_b16 v[108:109], v101 offset:57600
    ds_read_b64_tr_b16 v[110:111], v101 offset:61696
    s_waitcnt lgkmcnt(10)
    v_mfma_f32_32x32x16_bf16 v[128:143], v[112:115], a[124:127], v[128:143]
    ds_read_b64_tr_b16 v[112:113], v102 offset:57600
    ds_read_b64_tr_b16 v[114:115], v102 offset:61696
    s_waitcnt lgkmcnt(10)
    v_mfma_f32_32x32x16_bf16 v[144:159], v[116:119], a[124:127], v[144:159]
    ds_read_b64_tr_b16 v[116:117], v103 offset:57600
    ds_read_b64_tr_b16 v[118:119], v103 offset:61696
    s_waitcnt lgkmcnt(10)
    v_mfma_f32_32x32x16_bf16 v[160:175], v[120:123], a[124:127], v[160:175]
    s_waitcnt lgkmcnt(8)
    v_mfma_f32_32x32x16_bf16 v[176:191], v[124:127], a[124:127], v[176:191]
    s_waitcnt lgkmcnt(6)
    v_mfma_f32_32x32x16_bf16 v[192:207], v[104:107], a[124:127], v[192:207]
    s_waitcnt lgkmcnt(4)
    v_mfma_f32_32x32x16_bf16 v[208:223], v[108:111], a[124:127], v[208:223]
    s_waitcnt lgkmcnt(2)
    v_mfma_f32_32x32x16_bf16 v[224:239], v[112:115], a[124:127], v[224:239]
    s_waitcnt lgkmcnt(0)
    v_mfma_f32_32x32x16_bf16 v[240:255], v[116:119], a[124:127], v[240:255]
    s_waitcnt vmcnt(20) lgkmcnt(0)
    s_barrier
    ds_read_b64_tr_b16 v[104:105], v28 offset:0
    ds_read_b64_tr_b16 v[106:107], v28 offset:4096
    ds_read_b64_tr_b16 v[108:109], v29 offset:0
    ds_read_b64_tr_b16 v[110:111], v29 offset:4096
    ds_read_b64_tr_b16 v[112:113], v30 offset:0
    ds_read_b64_tr_b16 v[114:115], v30 offset:4096
    ds_read_b64_tr_b16 v[116:117], v31 offset:0
    ds_read_b64_tr_b16 v[118:119], v31 offset:4096
    ds_read_b64_tr_b16 v[120:121], v28 offset:256
    ds_read_b64_tr_b16 v[122:123], v28 offset:4352
    ds_read_b64_tr_b16 v[124:125], v29 offset:256
    ds_read_b64_tr_b16 v[126:127], v29 offset:4352
    s_waitcnt lgkmcnt(10)
    v_mfma_f32_32x32x16_bf16 v[128:143], v[104:107], a[128:131], v[128:143]
    ds_read_b64_tr_b16 v[104:105], v30 offset:256
    ds_read_b64_tr_b16 v[106:107], v30 offset:4352
    s_waitcnt lgkmcnt(10)
    v_mfma_f32_32x32x16_bf16 v[144:159], v[108:111], a[128:131], v[144:159]
    ds_read_b64_tr_b16 v[108:109], v31 offset:256
    ds_read_b64_tr_b16 v[110:111], v31 offset:4352
    s_waitcnt lgkmcnt(10)
    v_mfma_f32_32x32x16_bf16 v[160:175], v[112:115], a[128:131], v[160:175]
    ds_read_b64_tr_b16 v[112:113], v28 offset:8192
    ds_read_b64_tr_b16 v[114:115], v28 offset:12288
    s_waitcnt lgkmcnt(10)
    v_mfma_f32_32x32x16_bf16 v[176:191], v[116:119], a[128:131], v[176:191]
    ds_read_b64_tr_b16 v[116:117], v29 offset:8192
    ds_read_b64_tr_b16 v[118:119], v29 offset:12288
    s_waitcnt lgkmcnt(10)
    v_mfma_f32_32x32x16_bf16 v[192:207], v[120:123], a[128:131], v[192:207]
    ds_read_b64_tr_b16 v[120:121], v30 offset:8192
    ds_read_b64_tr_b16 v[122:123], v30 offset:12288
    s_waitcnt lgkmcnt(10)
    v_mfma_f32_32x32x16_bf16 v[208:223], v[124:127], a[128:131], v[208:223]
    ds_read_b64_tr_b16 v[124:125], v31 offset:8192
    ds_read_b64_tr_b16 v[126:127], v31 offset:12288
    s_waitcnt lgkmcnt(10)
    v_mfma_f32_32x32x16_bf16 v[224:239], v[104:107], a[128:131], v[224:239]
    ds_read_b64_tr_b16 v[104:105], v28 offset:8448
    ds_read_b64_tr_b16 v[106:107], v28 offset:12544
    s_waitcnt lgkmcnt(10)
    v_mfma_f32_32x32x16_bf16 v[240:255], v[108:111], a[128:131], v[240:255]
    ds_read_b64_tr_b16 v[108:109], v29 offset:8448
    ds_read_b64_tr_b16 v[110:111], v29 offset:12544
    s_waitcnt lgkmcnt(10)
    v_mfma_f32_32x32x16_bf16 v[128:143], v[112:115], a[132:135], v[128:143]
    ds_read_b64_tr_b16 v[112:113], v30 offset:8448
    ds_read_b64_tr_b16 v[114:115], v30 offset:12544
    s_waitcnt lgkmcnt(10)
    v_mfma_f32_32x32x16_bf16 v[144:159], v[116:119], a[132:135], v[144:159]
    ds_read_b64_tr_b16 v[116:117], v31 offset:8448
    ds_read_b64_tr_b16 v[118:119], v31 offset:12544
    s_waitcnt lgkmcnt(10)
    v_mfma_f32_32x32x16_bf16 v[160:175], v[120:123], a[132:135], v[160:175]
    s_waitcnt lgkmcnt(8)
    v_mfma_f32_32x32x16_bf16 v[176:191], v[124:127], a[132:135], v[176:191]
    s_waitcnt lgkmcnt(6)
    v_mfma_f32_32x32x16_bf16 v[192:207], v[104:107], a[132:135], v[192:207]
    s_waitcnt lgkmcnt(4)
    v_mfma_f32_32x32x16_bf16 v[208:223], v[108:111], a[132:135], v[208:223]
    s_waitcnt lgkmcnt(2)
    v_mfma_f32_32x32x16_bf16 v[224:239], v[112:115], a[132:135], v[224:239]
    s_waitcnt lgkmcnt(0)
    v_mfma_f32_32x32x16_bf16 v[240:255], v[116:119], a[132:135], v[240:255]
    s_waitcnt vmcnt(16) lgkmcnt(0)
    s_barrier
    ds_read_b64_tr_b16 v[104:105], v28 offset:16384
    ds_read_b64_tr_b16 v[106:107], v28 offset:20480
    ds_read_b64_tr_b16 v[108:109], v29 offset:16384
    ds_read_b64_tr_b16 v[110:111], v29 offset:20480
    ds_read_b64_tr_b16 v[112:113], v30 offset:16384
    ds_read_b64_tr_b16 v[114:115], v30 offset:20480
    ds_read_b64_tr_b16 v[116:117], v31 offset:16384
    ds_read_b64_tr_b16 v[118:119], v31 offset:20480
    ds_read_b64_tr_b16 v[120:121], v28 offset:16640
    ds_read_b64_tr_b16 v[122:123], v28 offset:20736
    ds_read_b64_tr_b16 v[124:125], v29 offset:16640
    ds_read_b64_tr_b16 v[126:127], v29 offset:20736
    s_waitcnt lgkmcnt(10)
    v_mfma_f32_32x32x16_bf16 v[128:143], v[104:107], a[136:139], v[128:143]
    ds_read_b64_tr_b16 v[104:105], v30 offset:16640
    ds_read_b64_tr_b16 v[106:107], v30 offset:20736
    s_waitcnt lgkmcnt(10)
    v_mfma_f32_32x32x16_bf16 v[144:159], v[108:111], a[136:139], v[144:159]
    ds_read_b64_tr_b16 v[108:109], v31 offset:16640
    ds_read_b64_tr_b16 v[110:111], v31 offset:20736
    s_waitcnt lgkmcnt(10)
    v_mfma_f32_32x32x16_bf16 v[160:175], v[112:115], a[136:139], v[160:175]
    ds_read_b64_tr_b16 v[112:113], v28 offset:24576
    ds_read_b64_tr_b16 v[114:115], v28 offset:28672
    s_waitcnt lgkmcnt(10)
    v_mfma_f32_32x32x16_bf16 v[176:191], v[116:119], a[136:139], v[176:191]
    ds_read_b64_tr_b16 v[116:117], v29 offset:24576
    ds_read_b64_tr_b16 v[118:119], v29 offset:28672
    s_waitcnt lgkmcnt(10)
    v_mfma_f32_32x32x16_bf16 v[192:207], v[120:123], a[136:139], v[192:207]
    ds_read_b64_tr_b16 v[120:121], v30 offset:24576
    ds_read_b64_tr_b16 v[122:123], v30 offset:28672
    s_waitcnt lgkmcnt(10)
    v_mfma_f32_32x32x16_bf16 v[208:223], v[124:127], a[136:139], v[208:223]
    ds_read_b64_tr_b16 v[124:125], v31 offset:24576
    ds_read_b64_tr_b16 v[126:127], v31 offset:28672
    s_waitcnt lgkmcnt(10)
    v_mfma_f32_32x32x16_bf16 v[224:239], v[104:107], a[136:139], v[224:239]
    ds_read_b64_tr_b16 v[104:105], v28 offset:24832
    ds_read_b64_tr_b16 v[106:107], v28 offset:28928
    s_waitcnt lgkmcnt(10)
    v_mfma_f32_32x32x16_bf16 v[240:255], v[108:111], a[136:139], v[240:255]
    ds_read_b64_tr_b16 v[108:109], v29 offset:24832
    ds_read_b64_tr_b16 v[110:111], v29 offset:28928
    s_waitcnt lgkmcnt(10)
    v_mfma_f32_32x32x16_bf16 v[128:143], v[112:115], a[140:143], v[128:143]
    ds_read_b64_tr_b16 v[112:113], v30 offset:24832
    ds_read_b64_tr_b16 v[114:115], v30 offset:28928
    s_waitcnt lgkmcnt(10)
    v_mfma_f32_32x32x16_bf16 v[144:159], v[116:119], a[140:143], v[144:159]
    ds_read_b64_tr_b16 v[116:117], v31 offset:24832
    ds_read_b64_tr_b16 v[118:119], v31 offset:28928
    s_waitcnt lgkmcnt(10)
    v_mfma_f32_32x32x16_bf16 v[160:175], v[120:123], a[140:143], v[160:175]
    s_waitcnt lgkmcnt(8)
    v_mfma_f32_32x32x16_bf16 v[176:191], v[124:127], a[140:143], v[176:191]
    s_waitcnt lgkmcnt(6)
    v_mfma_f32_32x32x16_bf16 v[192:207], v[104:107], a[140:143], v[192:207]
    s_waitcnt lgkmcnt(4)
    v_mfma_f32_32x32x16_bf16 v[208:223], v[108:111], a[140:143], v[208:223]
    s_waitcnt lgkmcnt(2)
    v_mfma_f32_32x32x16_bf16 v[224:239], v[112:115], a[140:143], v[224:239]
    s_waitcnt lgkmcnt(0)
    v_mfma_f32_32x32x16_bf16 v[240:255], v[116:119], a[140:143], v[240:255]
    s_waitcnt vmcnt(12) lgkmcnt(0)
    s_barrier
    ds_read_b64_tr_b16 v[104:105], v28 offset:32768
    ds_read_b64_tr_b16 v[106:107], v28 offset:36864
    ds_read_b64_tr_b16 v[108:109], v29 offset:32768
    ds_read_b64_tr_b16 v[110:111], v29 offset:36864
    ds_read_b64_tr_b16 v[112:113], v30 offset:32768
    ds_read_b64_tr_b16 v[114:115], v30 offset:36864
    ds_read_b64_tr_b16 v[116:117], v31 offset:32768
    ds_read_b64_tr_b16 v[118:119], v31 offset:36864
    ds_read_b64_tr_b16 v[120:121], v28 offset:33024
    ds_read_b64_tr_b16 v[122:123], v28 offset:37120
    ds_read_b64_tr_b16 v[124:125], v29 offset:33024
    ds_read_b64_tr_b16 v[126:127], v29 offset:37120
    s_waitcnt lgkmcnt(10)
    v_mfma_f32_32x32x16_bf16 v[128:143], v[104:107], a[144:147], v[128:143]
    ds_read_b64_tr_b16 v[104:105], v30 offset:33024
    ds_read_b64_tr_b16 v[106:107], v30 offset:37120
    s_waitcnt lgkmcnt(10)
    v_mfma_f32_32x32x16_bf16 v[144:159], v[108:111], a[144:147], v[144:159]
    ds_read_b64_tr_b16 v[108:109], v31 offset:33024
    ds_read_b64_tr_b16 v[110:111], v31 offset:37120
    s_waitcnt lgkmcnt(10)
    v_mfma_f32_32x32x16_bf16 v[160:175], v[112:115], a[144:147], v[160:175]
    ds_read_b64_tr_b16 v[112:113], v28 offset:40960
    ds_read_b64_tr_b16 v[114:115], v28 offset:45056
    s_waitcnt lgkmcnt(10)
    v_mfma_f32_32x32x16_bf16 v[176:191], v[116:119], a[144:147], v[176:191]
    ds_read_b64_tr_b16 v[116:117], v29 offset:40960
    ds_read_b64_tr_b16 v[118:119], v29 offset:45056
    s_waitcnt lgkmcnt(10)
    v_mfma_f32_32x32x16_bf16 v[192:207], v[120:123], a[144:147], v[192:207]
    ds_read_b64_tr_b16 v[120:121], v30 offset:40960
    ds_read_b64_tr_b16 v[122:123], v30 offset:45056
    s_waitcnt lgkmcnt(10)
    v_mfma_f32_32x32x16_bf16 v[208:223], v[124:127], a[144:147], v[208:223]
    ds_read_b64_tr_b16 v[124:125], v31 offset:40960
    ds_read_b64_tr_b16 v[126:127], v31 offset:45056
    s_waitcnt lgkmcnt(10)
    v_mfma_f32_32x32x16_bf16 v[224:239], v[104:107], a[144:147], v[224:239]
    ds_read_b64_tr_b16 v[104:105], v28 offset:41216
    ds_read_b64_tr_b16 v[106:107], v28 offset:45312
    s_waitcnt lgkmcnt(10)
    v_mfma_f32_32x32x16_bf16 v[240:255], v[108:111], a[144:147], v[240:255]
    ds_read_b64_tr_b16 v[108:109], v29 offset:41216
    ds_read_b64_tr_b16 v[110:111], v29 offset:45312
    s_waitcnt lgkmcnt(10)
    v_mfma_f32_32x32x16_bf16 v[128:143], v[112:115], a[148:151], v[128:143]
    ds_read_b64_tr_b16 v[112:113], v30 offset:41216
    ds_read_b64_tr_b16 v[114:115], v30 offset:45312
    s_waitcnt lgkmcnt(10)
    v_mfma_f32_32x32x16_bf16 v[144:159], v[116:119], a[148:151], v[144:159]
    ds_read_b64_tr_b16 v[116:117], v31 offset:41216
    ds_read_b64_tr_b16 v[118:119], v31 offset:45312
    s_waitcnt lgkmcnt(10)
    v_mfma_f32_32x32x16_bf16 v[160:175], v[120:123], a[148:151], v[160:175]
    s_waitcnt lgkmcnt(8)
    v_mfma_f32_32x32x16_bf16 v[176:191], v[124:127], a[148:151], v[176:191]
    s_waitcnt lgkmcnt(6)
    v_mfma_f32_32x32x16_bf16 v[192:207], v[104:107], a[148:151], v[192:207]
    s_waitcnt lgkmcnt(4)
    v_mfma_f32_32x32x16_bf16 v[208:223], v[108:111], a[148:151], v[208:223]
    s_waitcnt lgkmcnt(2)
    v_mfma_f32_32x32x16_bf16 v[224:239], v[112:115], a[148:151], v[224:239]
    s_waitcnt lgkmcnt(0)
    v_mfma_f32_32x32x16_bf16 v[240:255], v[116:119], a[148:151], v[240:255]
    s_waitcnt vmcnt(8) lgkmcnt(0)
    s_barrier
    ds_read_b64_tr_b16 v[104:105], v28 offset:49152
    ds_read_b64_tr_b16 v[106:107], v28 offset:53248
    ds_read_b64_tr_b16 v[108:109], v29 offset:49152
    ds_read_b64_tr_b16 v[110:111], v29 offset:53248
    ds_read_b64_tr_b16 v[112:113], v30 offset:49152
    ds_read_b64_tr_b16 v[114:115], v30 offset:53248
    ds_read_b64_tr_b16 v[116:117], v31 offset:49152
    ds_read_b64_tr_b16 v[118:119], v31 offset:53248
    ds_read_b64_tr_b16 v[120:121], v28 offset:49408
    ds_read_b64_tr_b16 v[122:123], v28 offset:53504
    ds_read_b64_tr_b16 v[124:125], v29 offset:49408
    ds_read_b64_tr_b16 v[126:127], v29 offset:53504
    s_waitcnt lgkmcnt(10)
    v_mfma_f32_32x32x16_bf16 v[128:143], v[104:107], a[152:155], v[128:143]
    ds_read_b64_tr_b16 v[104:105], v30 offset:49408
    ds_read_b64_tr_b16 v[106:107], v30 offset:53504
    s_waitcnt lgkmcnt(10)
    v_mfma_f32_32x32x16_bf16 v[144:159], v[108:111], a[152:155], v[144:159]
    ds_read_b64_tr_b16 v[108:109], v31 offset:49408
    ds_read_b64_tr_b16 v[110:111], v31 offset:53504
    s_waitcnt lgkmcnt(10)
    v_mfma_f32_32x32x16_bf16 v[160:175], v[112:115], a[152:155], v[160:175]
    ds_read_b64_tr_b16 v[112:113], v28 offset:57344
    ds_read_b64_tr_b16 v[114:115], v28 offset:61440
    s_waitcnt lgkmcnt(10)
    v_mfma_f32_32x32x16_bf16 v[176:191], v[116:119], a[152:155], v[176:191]
    ds_read_b64_tr_b16 v[116:117], v29 offset:57344
    ds_read_b64_tr_b16 v[118:119], v29 offset:61440
    s_waitcnt lgkmcnt(10)
    v_mfma_f32_32x32x16_bf16 v[192:207], v[120:123], a[152:155], v[192:207]
    ds_read_b64_tr_b16 v[120:121], v30 offset:57344
    ds_read_b64_tr_b16 v[122:123], v30 offset:61440
    s_waitcnt lgkmcnt(10)
    v_mfma_f32_32x32x16_bf16 v[208:223], v[124:127], a[152:155], v[208:223]
    ds_read_b64_tr_b16 v[124:125], v31 offset:57344
    ds_read_b64_tr_b16 v[126:127], v31 offset:61440
    s_waitcnt lgkmcnt(10)
    v_mfma_f32_32x32x16_bf16 v[224:239], v[104:107], a[152:155], v[224:239]
    ds_read_b64_tr_b16 v[104:105], v28 offset:57600
    ds_read_b64_tr_b16 v[106:107], v28 offset:61696
    s_waitcnt lgkmcnt(10)
    v_mfma_f32_32x32x16_bf16 v[240:255], v[108:111], a[152:155], v[240:255]
    ds_read_b64_tr_b16 v[108:109], v29 offset:57600
    ds_read_b64_tr_b16 v[110:111], v29 offset:61696
    s_waitcnt lgkmcnt(10)
    v_mfma_f32_32x32x16_bf16 v[128:143], v[112:115], a[156:159], v[128:143]
    ds_read_b64_tr_b16 v[112:113], v30 offset:57600
    ds_read_b64_tr_b16 v[114:115], v30 offset:61696
    s_waitcnt lgkmcnt(10)
    v_mfma_f32_32x32x16_bf16 v[144:159], v[116:119], a[156:159], v[144:159]
    ds_read_b64_tr_b16 v[116:117], v31 offset:57600
    ds_read_b64_tr_b16 v[118:119], v31 offset:61696
    s_waitcnt lgkmcnt(10)
    v_mfma_f32_32x32x16_bf16 v[160:175], v[120:123], a[156:159], v[160:175]
    s_waitcnt lgkmcnt(8)
    v_mfma_f32_32x32x16_bf16 v[176:191], v[124:127], a[156:159], v[176:191]
    s_waitcnt lgkmcnt(6)
    v_mfma_f32_32x32x16_bf16 v[192:207], v[104:107], a[156:159], v[192:207]
    s_waitcnt lgkmcnt(4)
    v_mfma_f32_32x32x16_bf16 v[208:223], v[108:111], a[156:159], v[208:223]
    s_waitcnt lgkmcnt(2)
    v_mfma_f32_32x32x16_bf16 v[224:239], v[112:115], a[156:159], v[224:239]
    s_waitcnt lgkmcnt(0)
    v_mfma_f32_32x32x16_bf16 v[240:255], v[116:119], a[156:159], v[240:255]
    s_waitcnt vmcnt(4) lgkmcnt(0)
    s_barrier
    ds_read_b64_tr_b16 v[104:105], v100 offset:0
    ds_read_b64_tr_b16 v[106:107], v100 offset:4096
    ds_read_b64_tr_b16 v[108:109], v101 offset:0
    ds_read_b64_tr_b16 v[110:111], v101 offset:4096
    ds_read_b64_tr_b16 v[112:113], v102 offset:0
    ds_read_b64_tr_b16 v[114:115], v102 offset:4096
    ds_read_b64_tr_b16 v[116:117], v103 offset:0
    ds_read_b64_tr_b16 v[118:119], v103 offset:4096
    ds_read_b64_tr_b16 v[120:121], v100 offset:256
    ds_read_b64_tr_b16 v[122:123], v100 offset:4352
    ds_read_b64_tr_b16 v[124:125], v101 offset:256
    ds_read_b64_tr_b16 v[126:127], v101 offset:4352
    s_waitcnt lgkmcnt(10)
    v_mfma_f32_32x32x16_bf16 v[128:143], v[104:107], a[160:163], v[128:143]
    ds_read_b64_tr_b16 v[104:105], v102 offset:256
    ds_read_b64_tr_b16 v[106:107], v102 offset:4352
    s_waitcnt lgkmcnt(10)
    v_mfma_f32_32x32x16_bf16 v[144:159], v[108:111], a[160:163], v[144:159]
    ds_read_b64_tr_b16 v[108:109], v103 offset:256
    ds_read_b64_tr_b16 v[110:111], v103 offset:4352
    s_waitcnt lgkmcnt(10)
    v_mfma_f32_32x32x16_bf16 v[160:175], v[112:115], a[160:163], v[160:175]
    ds_read_b64_tr_b16 v[112:113], v100 offset:8192
    ds_read_b64_tr_b16 v[114:115], v100 offset:12288
    s_waitcnt lgkmcnt(10)
    v_mfma_f32_32x32x16_bf16 v[176:191], v[116:119], a[160:163], v[176:191]
    ds_read_b64_tr_b16 v[116:117], v101 offset:8192
    ds_read_b64_tr_b16 v[118:119], v101 offset:12288
    s_waitcnt lgkmcnt(10)
    v_mfma_f32_32x32x16_bf16 v[192:207], v[120:123], a[160:163], v[192:207]
    ds_read_b64_tr_b16 v[120:121], v102 offset:8192
    ds_read_b64_tr_b16 v[122:123], v102 offset:12288
    s_waitcnt lgkmcnt(10)
    v_mfma_f32_32x32x16_bf16 v[208:223], v[124:127], a[160:163], v[208:223]
    ds_read_b64_tr_b16 v[124:125], v103 offset:8192
    ds_read_b64_tr_b16 v[126:127], v103 offset:12288
    s_waitcnt lgkmcnt(10)
    v_mfma_f32_32x32x16_bf16 v[224:239], v[104:107], a[160:163], v[224:239]
    ds_read_b64_tr_b16 v[104:105], v100 offset:8448
    ds_read_b64_tr_b16 v[106:107], v100 offset:12544
    s_waitcnt lgkmcnt(10)
    v_mfma_f32_32x32x16_bf16 v[240:255], v[108:111], a[160:163], v[240:255]
    ds_read_b64_tr_b16 v[108:109], v101 offset:8448
    ds_read_b64_tr_b16 v[110:111], v101 offset:12544
    s_waitcnt lgkmcnt(10)
    v_mfma_f32_32x32x16_bf16 v[128:143], v[112:115], a[164:167], v[128:143]
    ds_read_b64_tr_b16 v[112:113], v102 offset:8448
    ds_read_b64_tr_b16 v[114:115], v102 offset:12544
    s_waitcnt lgkmcnt(10)
    v_mfma_f32_32x32x16_bf16 v[144:159], v[116:119], a[164:167], v[144:159]
    ds_read_b64_tr_b16 v[116:117], v103 offset:8448
    ds_read_b64_tr_b16 v[118:119], v103 offset:12544
    s_waitcnt lgkmcnt(10)
    v_mfma_f32_32x32x16_bf16 v[160:175], v[120:123], a[164:167], v[160:175]
    s_waitcnt lgkmcnt(8)
    v_mfma_f32_32x32x16_bf16 v[176:191], v[124:127], a[164:167], v[176:191]
    s_waitcnt lgkmcnt(6)
    v_mfma_f32_32x32x16_bf16 v[192:207], v[104:107], a[164:167], v[192:207]
    s_waitcnt lgkmcnt(4)
    v_mfma_f32_32x32x16_bf16 v[208:223], v[108:111], a[164:167], v[208:223]
    s_waitcnt lgkmcnt(2)
    v_mfma_f32_32x32x16_bf16 v[224:239], v[112:115], a[164:167], v[224:239]
    s_waitcnt lgkmcnt(0)
    v_mfma_f32_32x32x16_bf16 v[240:255], v[116:119], a[164:167], v[240:255]
    s_waitcnt vmcnt(0) lgkmcnt(0)
    s_barrier
    ds_read_b64_tr_b16 v[104:105], v100 offset:16384
    ds_read_b64_tr_b16 v[106:107], v100 offset:20480
    ds_read_b64_tr_b16 v[108:109], v101 offset:16384
    ds_read_b64_tr_b16 v[110:111], v101 offset:20480
    ds_read_b64_tr_b16 v[112:113], v102 offset:16384
    ds_read_b64_tr_b16 v[114:115], v102 offset:20480
    ds_read_b64_tr_b16 v[116:117], v103 offset:16384
    ds_read_b64_tr_b16 v[118:119], v103 offset:20480
    ds_read_b64_tr_b16 v[120:121], v100 offset:16640
    ds_read_b64_tr_b16 v[122:123], v100 offset:20736
    ds_read_b64_tr_b16 v[124:125], v101 offset:16640
    ds_read_b64_tr_b16 v[126:127], v101 offset:20736
    s_waitcnt lgkmcnt(10)
    v_mfma_f32_32x32x16_bf16 v[128:143], v[104:107], a[168:171], v[128:143]
    ds_read_b64_tr_b16 v[104:105], v102 offset:16640
    ds_read_b64_tr_b16 v[106:107], v102 offset:20736
    s_waitcnt lgkmcnt(10)
    v_mfma_f32_32x32x16_bf16 v[144:159], v[108:111], a[168:171], v[144:159]
    ds_read_b64_tr_b16 v[108:109], v103 offset:16640
    ds_read_b64_tr_b16 v[110:111], v103 offset:20736
    s_waitcnt lgkmcnt(10)
    v_mfma_f32_32x32x16_bf16 v[160:175], v[112:115], a[168:171], v[160:175]
    ds_read_b64_tr_b16 v[112:113], v100 offset:24576
    ds_read_b64_tr_b16 v[114:115], v100 offset:28672
    s_waitcnt lgkmcnt(10)
    v_mfma_f32_32x32x16_bf16 v[176:191], v[116:119], a[168:171], v[176:191]
    ds_read_b64_tr_b16 v[116:117], v101 offset:24576
    ds_read_b64_tr_b16 v[118:119], v101 offset:28672
    s_waitcnt lgkmcnt(10)
    v_mfma_f32_32x32x16_bf16 v[192:207], v[120:123], a[168:171], v[192:207]
    ds_read_b64_tr_b16 v[120:121], v102 offset:24576
    ds_read_b64_tr_b16 v[122:123], v102 offset:28672
    s_waitcnt lgkmcnt(10)
    v_mfma_f32_32x32x16_bf16 v[208:223], v[124:127], a[168:171], v[208:223]
    ds_read_b64_tr_b16 v[124:125], v103 offset:24576
    ds_read_b64_tr_b16 v[126:127], v103 offset:28672
    s_waitcnt lgkmcnt(10)
    v_mfma_f32_32x32x16_bf16 v[224:239], v[104:107], a[168:171], v[224:239]
    ds_read_b64_tr_b16 v[104:105], v100 offset:24832
    ds_read_b64_tr_b16 v[106:107], v100 offset:28928
    s_waitcnt lgkmcnt(10)
    v_mfma_f32_32x32x16_bf16 v[240:255], v[108:111], a[168:171], v[240:255]
    ds_read_b64_tr_b16 v[108:109], v101 offset:24832
    ds_read_b64_tr_b16 v[110:111], v101 offset:28928
    s_waitcnt lgkmcnt(10)
    v_mfma_f32_32x32x16_bf16 v[128:143], v[112:115], a[172:175], v[128:143]
    ds_read_b64_tr_b16 v[112:113], v102 offset:24832
    ds_read_b64_tr_b16 v[114:115], v102 offset:28928
    s_waitcnt lgkmcnt(10)
    v_mfma_f32_32x32x16_bf16 v[144:159], v[116:119], a[172:175], v[144:159]
    ds_read_b64_tr_b16 v[116:117], v103 offset:24832
    ds_read_b64_tr_b16 v[118:119], v103 offset:28928
    s_waitcnt lgkmcnt(10)
    v_mfma_f32_32x32x16_bf16 v[160:175], v[120:123], a[172:175], v[160:175]
    s_waitcnt lgkmcnt(8)
    v_mfma_f32_32x32x16_bf16 v[176:191], v[124:127], a[172:175], v[176:191]
    s_waitcnt lgkmcnt(6)
    v_mfma_f32_32x32x16_bf16 v[192:207], v[104:107], a[172:175], v[192:207]
    s_waitcnt lgkmcnt(4)
    v_mfma_f32_32x32x16_bf16 v[208:223], v[108:111], a[172:175], v[208:223]
    s_waitcnt lgkmcnt(2)
    v_mfma_f32_32x32x16_bf16 v[224:239], v[112:115], a[172:175], v[224:239]
    s_waitcnt lgkmcnt(0)
    v_mfma_f32_32x32x16_bf16 v[240:255], v[116:119], a[172:175], v[240:255]
    s_barrier
    s_add_u32 s45, s46, 32768
    s_mov_b32 m0, s45
    s_nop 0
    buffer_load_dwordx4 v12, s[12:15], s43 offen offset:0 lds
    buffer_load_dwordx4 v13, s[12:15], s43 offen offset:1024 lds
    buffer_load_dwordx4 v14, s[12:15], s43 offen offset:2048 lds
    buffer_load_dwordx4 v15, s[12:15], s43 offen offset:3072 lds
    s_add_u32 s45, s46, 98304
    s_mov_b32 m0, s45
    s_nop 0
    buffer_load_dwordx4 v16, s[16:19], s43 offen offset:0 lds
    buffer_load_dwordx4 v17, s[16:19], s43 offen offset:1024 lds
    buffer_load_dwordx4 v16, s[16:19], s43 offen offset:2048 lds
    buffer_load_dwordx4 v17, s[16:19], s43 offen offset:3072 lds
    s_add_u32 s43, s43, 16384
    s_add_u32 s45, s46, 49152
    s_mov_b32 m0, s45
    s_nop 0
    buffer_load_dwordx4 v12, s[12:15], s43 offen offset:0 lds
    buffer_load_dwordx4 v13, s[12:15], s43 offen offset:1024 lds
    buffer_load_dwordx4 v14, s[12:15], s43 offen offset:2048 lds
    buffer_load_dwordx4 v15, s[12:15], s43 offen offset:3072 lds
    s_add_u32 s45, s46, 114688
    s_mov_b32 m0, s45
    s_nop 0
    buffer_load_dwordx4 v16, s[16:19], s43 offen offset:0 lds
    buffer_load_dwordx4 v17, s[16:19], s43 offen offset:1024 lds
    buffer_load_dwordx4 v16, s[16:19], s43 offen offset:2048 lds
    buffer_load_dwordx4 v17, s[16:19], s43 offen offset:3072 lds
    s_add_u32 s43, s43, 16384
    s_add_u32 s45, s46, 0
    s_mov_b32 m0, s45
    s_nop 0
    buffer_load_dwordx4 v12, s[12:15], s43 offen offset:0 lds
    buffer_load_dwordx4 v13, s[12:15], s43 offen offset:1024 lds
    buffer_load_dwordx4 v14, s[12:15], s43 offen offset:2048 lds
    buffer_load_dwordx4 v15, s[12:15], s43 offen offset:3072 lds
    s_add_u32 s45, s46, 65536
    s_mov_b32 m0, s45
    s_nop 0
    buffer_load_dwordx4 v16, s[16:19], s43 offen offset:0 lds
    buffer_load_dwordx4 v17, s[16:19], s43 offen offset:1024 lds
    buffer_load_dwordx4 v16, s[16:19], s43 offen offset:2048 lds
    buffer_load_dwordx4 v17, s[16:19], s43 offen offset:3072 lds
    s_add_u32 s43, s43, 16384
    s_nop 7
    s_nop 7
    v_cvt_pk_bf16_f32 v2, v128, v129
    v_cvt_pk_bf16_f32 v3, v130, v131
    v_cvt_pk_bf16_f32 v4, v132, v133
    v_cvt_pk_bf16_f32 v5, v134, v135
    s_nop 1
    v_permlane32_swap_b32 v2, v4
    v_permlane32_swap_b32 v3, v5
    s_nop 1
    v_accvgpr_write_b32 a0, v2
    v_accvgpr_write_b32 a1, v3
    v_accvgpr_write_b32 a2, v4
    v_accvgpr_write_b32 a3, v5
    v_cvt_pk_bf16_f32 v2, v136, v137
    v_cvt_pk_bf16_f32 v3, v138, v139
    v_cvt_pk_bf16_f32 v4, v140, v141
    v_cvt_pk_bf16_f32 v5, v142, v143
    s_nop 1
    v_permlane32_swap_b32 v2, v4
    v_permlane32_swap_b32 v3, v5
    s_nop 1
    v_accvgpr_write_b32 a4, v2
    v_accvgpr_write_b32 a5, v3
    v_accvgpr_write_b32 a6, v4
    v_accvgpr_write_b32 a7, v5
    v_cvt_pk_bf16_f32 v2, v144, v145
    v_cvt_pk_bf16_f32 v3, v146, v147
    v_cvt_pk_bf16_f32 v4, v148, v149
    v_cvt_pk_bf16_f32 v5, v150, v151
    s_nop 1
    v_permlane32_swap_b32 v2, v4
    v_permlane32_swap_b32 v3, v5
    s_nop 1
    v_accvgpr_write_b32 a8, v2
    v_accvgpr_write_b32 a9, v3
    v_accvgpr_write_b32 a10, v4
    v_accvgpr_write_b32 a11, v5
    v_cvt_pk_bf16_f32 v2, v152, v153
    v_cvt_pk_bf16_f32 v3, v154, v155
    v_cvt_pk_bf16_f32 v4, v156, v157
    v_cvt_pk_bf16_f32 v5, v158, v159
    s_nop 1
    v_permlane32_swap_b32 v2, v4
    v_permlane32_swap_b32 v3, v5
    s_nop 1
    v_accvgpr_write_b32 a12, v2
    v_accvgpr_write_b32 a13, v3
    v_accvgpr_write_b32 a14, v4
    v_accvgpr_write_b32 a15, v5
    v_cvt_pk_bf16_f32 v2, v160, v161
    v_cvt_pk_bf16_f32 v3, v162, v163
    v_cvt_pk_bf16_f32 v4, v164, v165
    v_cvt_pk_bf16_f32 v5, v166, v167
    s_nop 1
    v_permlane32_swap_b32 v2, v4
    v_permlane32_swap_b32 v3, v5
    s_nop 1
    v_accvgpr_write_b32 a16, v2
    v_accvgpr_write_b32 a17, v3
    v_accvgpr_write_b32 a18, v4
    v_accvgpr_write_b32 a19, v5
    v_cvt_pk_bf16_f32 v2, v168, v169
    v_cvt_pk_bf16_f32 v3, v170, v171
    v_cvt_pk_bf16_f32 v4, v172, v173
    v_cvt_pk_bf16_f32 v5, v174, v175
    s_nop 1
    v_permlane32_swap_b32 v2, v4
    v_permlane32_swap_b32 v3, v5
    s_nop 1
    v_accvgpr_write_b32 a20, v2
    v_accvgpr_write_b32 a21, v3
    v_accvgpr_write_b32 a22, v4
    v_accvgpr_write_b32 a23, v5
    v_cvt_pk_bf16_f32 v2, v176, v177
    v_cvt_pk_bf16_f32 v3, v178, v179
    v_cvt_pk_bf16_f32 v4, v180, v181
    v_cvt_pk_bf16_f32 v5, v182, v183
    s_nop 1
    v_permlane32_swap_b32 v2, v4
    v_permlane32_swap_b32 v3, v5
    s_nop 1
    v_accvgpr_write_b32 a24, v2
    v_accvgpr_write_b32 a25, v3
    v_accvgpr_write_b32 a26, v4
    v_accvgpr_write_b32 a27, v5
    v_cvt_pk_bf16_f32 v2, v184, v185
    v_cvt_pk_bf16_f32 v3, v186, v187
    v_cvt_pk_bf16_f32 v4, v188, v189
    v_cvt_pk_bf16_f32 v5, v190, v191
    s_nop 1
    v_permlane32_swap_b32 v2, v4
    v_permlane32_swap_b32 v3, v5
    s_nop 1
    v_accvgpr_write_b32 a28, v2
    v_accvgpr_write_b32 a29, v3
    v_accvgpr_write_b32 a30, v4
    v_accvgpr_write_b32 a31, v5
    v_cvt_pk_bf16_f32 v2, v192, v193
    v_cvt_pk_bf16_f32 v3, v194, v195
    v_cvt_pk_bf16_f32 v4, v196, v197
    v_cvt_pk_bf16_f32 v5, v198, v199
    s_nop 1
    v_permlane32_swap_b32 v2, v4
    v_permlane32_swap_b32 v3, v5
    s_nop 1
    v_accvgpr_write_b32 a32, v2
    v_accvgpr_write_b32 a33, v3
    v_accvgpr_write_b32 a34, v4
    v_accvgpr_write_b32 a35, v5
    v_cvt_pk_bf16_f32 v2, v200, v201
    v_cvt_pk_bf16_f32 v3, v202, v203
    v_cvt_pk_bf16_f32 v4, v204, v205
    v_cvt_pk_bf16_f32 v5, v206, v207
    s_nop 1
    v_permlane32_swap_b32 v2, v4
    v_permlane32_swap_b32 v3, v5
    s_nop 1
    v_accvgpr_write_b32 a36, v2
    v_accvgpr_write_b32 a37, v3
    v_accvgpr_write_b32 a38, v4
    v_accvgpr_write_b32 a39, v5
    v_cvt_pk_bf16_f32 v2, v208, v209
    v_cvt_pk_bf16_f32 v3, v210, v211
    v_cvt_pk_bf16_f32 v4, v212, v213
    v_cvt_pk_bf16_f32 v5, v214, v215
    s_nop 1
    v_permlane32_swap_b32 v2, v4
    v_permlane32_swap_b32 v3, v5
    s_nop 1
    v_accvgpr_write_b32 a40, v2
    v_accvgpr_write_b32 a41, v3
    v_accvgpr_write_b32 a42, v4
    v_accvgpr_write_b32 a43, v5
    v_cvt_pk_bf16_f32 v2, v216, v217
    v_cvt_pk_bf16_f32 v3, v218, v219
    v_cvt_pk_bf16_f32 v4, v220, v221
    v_cvt_pk_bf16_f32 v5, v222, v223
    s_nop 1
    v_permlane32_swap_b32 v2, v4
    v_permlane32_swap_b32 v3, v5
    s_nop 1
    v_accvgpr_write_b32 a44, v2
    v_accvgpr_write_b32 a45, v3
    v_accvgpr_write_b32 a46, v4
    v_accvgpr_write_b32 a47, v5
    v_cvt_pk_bf16_f32 v2, v224, v225
    v_cvt_pk_bf16_f32 v3, v226, v227
    v_cvt_pk_bf16_f32 v4, v228, v229
    v_cvt_pk_bf16_f32 v5, v230, v231
    s_nop 1
    v_permlane32_swap_b32 v2, v4
    v_permlane32_swap_b32 v3, v5
    s_nop 1
    v_accvgpr_write_b32 a48, v2
    v_accvgpr_write_b32 a49, v3
    v_accvgpr_write_b32 a50, v4
    v_accvgpr_write_b32 a51, v5
    v_cvt_pk_bf16_f32 v2, v232, v233
    v_cvt_pk_bf16_f32 v3, v234, v235
    v_cvt_pk_bf16_f32 v4, v236, v237
    v_cvt_pk_bf16_f32 v5, v238, v239
    s_nop 1
    v_permlane32_swap_b32 v2, v4
    v_permlane32_swap_b32 v3, v5
    s_nop 1
    v_accvgpr_write_b32 a52, v2
    v_accvgpr_write_b32 a53, v3
    v_accvgpr_write_b32 a54, v4
    v_accvgpr_write_b32 a55, v5
    v_cvt_pk_bf16_f32 v2, v240, v241
    v_cvt_pk_bf16_f32 v3, v242, v243
    v_cvt_pk_bf16_f32 v4, v244, v245
    v_cvt_pk_bf16_f32 v5, v246, v247
    s_nop 1
    v_permlane32_swap_b32 v2, v4
    v_permlane32_swap_b32 v3, v5
    s_nop 1
    v_accvgpr_write_b32 a56, v2
    v_accvgpr_write_b32 a57, v3
    v_accvgpr_write_b32 a58, v4
    v_accvgpr_write_b32 a59, v5
    v_cvt_pk_bf16_f32 v2, v248, v249
    v_cvt_pk_bf16_f32 v3, v250, v251
    v_cvt_pk_bf16_f32 v4, v252, v253
    v_cvt_pk_bf16_f32 v5, v254, v255
    s_nop 1
    v_permlane32_swap_b32 v2, v4
    v_permlane32_swap_b32 v3, v5
    s_nop 1
    v_accvgpr_write_b32 a60, v2
    v_accvgpr_write_b32 a61, v3
    v_accvgpr_write_b32 a62, v4
    v_accvgpr_write_b32 a63, v5
    v_mov_b32 v128, 0
    v_mov_b32 v129, 0
    v_mov_b32 v130, 0
    v_mov_b32 v131, 0
    v_mov_b32 v132, 0
    v_mov_b32 v133, 0
    v_mov_b32 v134, 0
    v_mov_b32 v135, 0
    v_mov_b32 v136, 0
    v_mov_b32 v137, 0
    v_mov_b32 v138, 0
    v_mov_b32 v139, 0
    v_mov_b32 v140, 0
    v_mov_b32 v141, 0
    v_mov_b32 v142, 0
    v_mov_b32 v143, 0
    v_mov_b32 v144, 0
    v_mov_b32 v145, 0
    v_mov_b32 v146, 0
    v_mov_b32 v147, 0
    v_mov_b32 v148, 0
    v_mov_b32 v149, 0
    v_mov_b32 v150, 0
    v_mov_b32 v151, 0
    v_mov_b32 v152, 0
    v_mov_b32 v153, 0
    v_mov_b32 v154, 0
    v_mov_b32 v155, 0
    v_mov_b32 v156, 0
    v_mov_b32 v157, 0
    v_mov_b32 v158, 0
    v_mov_b32 v159, 0
    v_mov_b32 v160, 0
    v_mov_b32 v161, 0
    v_mov_b32 v162, 0
    v_mov_b32 v163, 0
    v_mov_b32 v164, 0
    v_mov_b32 v165, 0
    v_mov_b32 v166, 0
    v_mov_b32 v167, 0
    v_mov_b32 v168, 0
    v_mov_b32 v169, 0
    v_mov_b32 v170, 0
    v_mov_b32 v171, 0
    v_mov_b32 v172, 0
    v_mov_b32 v173, 0
    v_mov_b32 v174, 0
    v_mov_b32 v175, 0
    v_mov_b32 v176, 0
    v_mov_b32 v177, 0
    v_mov_b32 v178, 0
    v_mov_b32 v179, 0
    v_mov_b32 v180, 0
    v_mov_b32 v181, 0
    v_mov_b32 v182, 0
    v_mov_b32 v183, 0
    v_mov_b32 v184, 0
    v_mov_b32 v185, 0
    v_mov_b32 v186, 0
    v_mov_b32 v187, 0
    v_mov_b32 v188, 0
    v_mov_b32 v189, 0
    v_mov_b32 v190, 0
    v_mov_b32 v191, 0
    v_mov_b32 v192, 0
    v_mov_b32 v193, 0
    v_mov_b32 v194, 0
    v_mov_b32 v195, 0
    v_mov_b32 v196, 0
    v_mov_b32 v197, 0
    v_mov_b32 v198, 0
    v_mov_b32 v199, 0
    v_mov_b32 v200, 0
    v_mov_b32 v201, 0
    v_mov_b32 v202, 0
    v_mov_b32 v203, 0
    v_mov_b32 v204, 0
    v_mov_b32 v205, 0
    v_mov_b32 v206, 0
    v_mov_b32 v207, 0
    v_mov_b32 v208, 0
    v_mov_b32 v209, 0
    v_mov_b32 v210, 0
    v_mov_b32 v211, 0
    v_mov_b32 v212, 0
    v_mov_b32 v213, 0
    v_mov_b32 v214, 0
    v_mov_b32 v215, 0
    v_mov_b32 v216, 0
    v_mov_b32 v217, 0
    v_mov_b32 v218, 0
    v_mov_b32 v219, 0
    v_mov_b32 v220, 0
    v_mov_b32 v221, 0
    v_mov_b32 v222, 0
    v_mov_b32 v223, 0
    v_mov_b32 v224, 0
    v_mov_b32 v225, 0
    v_mov_b32 v226, 0
    v_mov_b32 v227, 0
    v_mov_b32 v228, 0
    v_mov_b32 v229, 0
    v_mov_b32 v230, 0
    v_mov_b32 v231, 0
    v_mov_b32 v232, 0
    v_mov_b32 v233, 0
    v_mov_b32 v234, 0
    v_mov_b32 v235, 0
    v_mov_b32 v236, 0
    v_mov_b32 v237, 0
    v_mov_b32 v238, 0
    v_mov_b32 v239, 0
    v_mov_b32 v240, 0
    v_mov_b32 v241, 0
    v_mov_b32 v242, 0
    v_mov_b32 v243, 0
    v_mov_b32 v244, 0
    v_mov_b32 v245, 0
    v_mov_b32 v246, 0
    v_mov_b32 v247, 0
    v_mov_b32 v248, 0
    v_mov_b32 v249, 0
    v_mov_b32 v250, 0
    v_mov_b32 v251, 0
    v_mov_b32 v252, 0
    v_mov_b32 v253, 0
    v_mov_b32 v254, 0
    v_mov_b32 v255, 0
    v_mov_b32 v6, 0xff7fffff
    v_mov_b32 v7, 0
    s_mov_b32 s44, 0
    s_waitcnt vmcnt(16) lgkmcnt(0)
    s_barrier
    ds_read_b128 v[32:35], v20 offset:32768
    ds_read_b128 v[36:39], v21 offset:32768
    ds_read_b128 v[40:43], v22 offset:32768
    ds_read_b128 v[44:47], v23 offset:32768
    ds_read_b128 v[48:51], v24 offset:32768
    ds_read_b128 v[52:55], v25 offset:32768
    ds_read_b128 v[56:59], v26 offset:32768
    ds_read_b128 v[60:63], v27 offset:32768
    s_waitcnt lgkmcnt(7)
    v_mfma_f32_32x32x16_bf16 v[72:87], v[32:35], a[0:3], 0
    ds_read_b128 v[32:35], v20 offset:33024
    s_waitcnt lgkmcnt(7)
    v_mfma_f32_32x32x16_bf16 v[72:87], v[36:39], a[4:7], v[72:87]
    ds_read_b128 v[36:39], v21 offset:33024
    s_waitcnt lgkmcnt(7)
    v_mfma_f32_32x32x16_bf16 v[72:87], v[40:43], a[8:11], v[72:87]
    ds_read_b128 v[40:43], v22 offset:33024
    s_waitcnt lgkmcnt(7)
    v_mfma_f32_32x32x16_bf16 v[72:87], v[44:47], a[12:15], v[72:87]
    ds_read_b128 v[44:47], v23 offset:33024
    s_waitcnt lgkmcnt(7)
    v_mfma_f32_32x32x16_bf16 v[72:87], v[48:51], a[16:19], v[72:87]
    ds_read_b128 v[48:51], v24 offset:33024
    s_waitcnt lgkmcnt(7)
    v_mfma_f32_32x32x16_bf16 v[72:87], v[52:55], a[20:23], v[72:87]
    ds_read_b128 v[52:55], v25 offset:33024
    s_waitcnt lgkmcnt(7)
    v_mfma_f32_32x32x16_bf16 v[72:87], v[56:59], a[24:27], v[72:87]
    ds_read_b128 v[56:59], v26 offset:33024
    s_waitcnt lgkmcnt(7)
    v_mfma_f32_32x32x16_bf16 v[72:87], v[60:63], a[28:31], v[72:87]
    ds_read_b128 v[60:63], v27 offset:33024
    s_waitcnt lgkmcnt(7)
    v_mfma_f32_32x32x16_bf16 v[72:87], v[32:35], a[32:35], v[72:87]
    s_waitcnt lgkmcnt(6)
    v_mfma_f32_32x32x16_bf16 v[72:87], v[36:39], a[36:39], v[72:87]
    s_waitcnt lgkmcnt(5)
    v_mfma_f32_32x32x16_bf16 v[72:87], v[40:43], a[40:43], v[72:87]
    s_waitcnt lgkmcnt(4)
    v_mfma_f32_32x32x16_bf16 v[72:87], v[44:47], a[44:47], v[72:87]
    s_waitcnt lgkmcnt(3)
    v_mfma_f32_32x32x16_bf16 v[72:87], v[48:51], a[48:51], v[72:87]
    s_waitcnt lgkmcnt(2)
    v_mfma_f32_32x32x16_bf16 v[72:87], v[52:55], a[52:55], v[72:87]
    s_waitcnt lgkmcnt(1)
    v_mfma_f32_32x32x16_bf16 v[72:87], v[56:59], a[56:59], v[72:87]
    s_waitcnt lgkmcnt(0)
    v_mfma_f32_32x32x16_bf16 v[72:87], v[60:63], a[60:63], v[72:87]
L_attn_loop:
    s_waitcnt vmcnt(8) lgkmcnt(0)
    s_barrier
    s_add_u32 s45, s46, 16384
    s_mov_b32 m0, s45
    s_nop 0
    buffer_load_dwordx4 v12, s[12:15], s43 offen offset:0 lds
    buffer_load_dwordx4 v13, s[12:15], s43 offen offset:1024 lds
    buffer_load_dwordx4 v14, s[12:15], s43 offen offset:2048 lds
    buffer_load_dwordx4 v15, s[12:15], s43 offen offset:3072 lds
    s_add_u32 s45, s46, 81920
    s_mov_b32 m0, s45
    s_nop 0
    buffer_load_dwordx4 v16, s[16:19], s43 offen offset:0 lds
    buffer_load_dwordx4 v17, s[16:19], s43 offen offset:1024 lds
    buffer_load_dwordx4 v16, s[16:19], s43 offen offset:2048 lds
    buffer_load_dwordx4 v17, s[16:19], s43 offen offset:3072 lds
    s_add_u32 s43, s43, 16384
    ds_read_b128 v[32:35], v20 offset:49152
    ds_read_b128 v[36:39], v21 offset:49152
    ds_read_b128 v[40:43], v22 offset:49152
    ds_read_b128 v[44:47], v23 offset:49152
    ds_read_b128 v[48:51], v24 offset:49152
    ds_read_b128 v[52:55], v25 offset:49152
    ds_read_b128 v[56:59], v26 offset:49152
    ds_read_b128 v[60:63], v27 offset:49152
    s_waitcnt lgkmcnt(7)
    v_mfma_f32_32x32x16_bf16 v[88:103], v[32:35], a[0:3], 0
    v_max3_f32 v2, v72, v73, v74
    v_max3_f32 v3, v75, v76, v77
    v_max3_f32 v4, v78, v79, v80
    v_max3_f32 v5, v81, v82, v83
    v_max3_f32 v2, v2, v84, v85
    ds_read_b128 v[32:35], v20 offset:49408
    s_waitcnt lgkmcnt(7)
    v_mfma_f32_32x32x16_bf16 v[88:103], v[36:39], a[4:7], v[88:103]
    v_max3_f32 v3, v3, v86, v87
    v_max3_f32 v2, v2, v3, v4
    v_max_f32 v2, v2, v5
    v_mov_b32 v3, v2
    ds_read_b128 v[36:39], v21 offset:49408
    s_waitcnt lgkmcnt(7)
    v_mfma_f32_32x32x16_bf16 v[88:103], v[40:43], a[8:11], v[88:103]
    v_permlane32_swap_b32 v2, v3
    s_nop 1
    v_max_f32 v2, v2, v3
    v_add_f32 v3, s50, v6
    v_cmp_gt_f32 vcc, v2, v3
    s_nop 3
    s_cbranch_vccz L_nors_0
    v_max_f32 v2, v2, v6
    v_sub_f32 v3, v6, v2
    v_mul_f32 v3, s42, v3
    v_exp_f32 v9, v3
    v_mov_b32 v6, v2
    v_mul_f32 v8, s42, v2
    v_mul_f32 v7, v7, v9
    v_mul_f32 v128, v9, v128
    v_mul_f32 v129, v9, v129
    v_mul_f32 v130, v9, v130
    v_mul_f32 v131, v9, v131
    v_mul_f32 v132, v9, v132
    v_mul_f32 v133, v9, v133
    v_mul_f32 v134, v9, v134
    v_mul_f32 v135, v9, v135
    v_mul_f32 v136, v9, v136
    v_mul_f32 v137, v9, v137
    v_mul_f32 v138, v9, v138
    v_mul_f32 v139, v9, v139
    v_mul_f32 v140, v9, v140
    v_mul_f32 v141, v9, v141
    v_mul_f32 v142, v9, v142
    v_mul_f32 v143, v9, v143
    v_mul_f32 v144, v9, v144
    v_mul_f32 v145, v9, v145
    v_mul_f32 v146, v9, v146
    v_mul_f32 v147, v9, v147
    v_mul_f32 v148, v9, v148
    v_mul_f32 v149, v9, v149
    v_mul_f32 v150, v9, v150
    v_mul_f32 v151, v9, v151
    v_mul_f32 v152, v9, v152
    v_mul_f32 v153, v9, v153
    v_mul_f32 v154, v9, v154
    v_mul_f32 v155, v9, v155
    v_mul_f32 v156, v9, v156
    v_mul_f32 v157, v9, v157
    v_mul_f32 v158, v9, v158
    v_mul_f32 v159, v9, v159
    v_mul_f32 v160, v9, v160
    v_mul_f32 v161, v9, v161
    v_mul_f32 v162, v9, v162
    v_mul_f32 v163, v9, v163
    v_mul_f32 v164, v9, v164
    v_mul_f32 v165, v9, v165
    v_mul_f32 v166, v9, v166
    v_mul_f32 v167, v9, v167
    v_mul_f32 v168, v9, v168
    v_mul_f32 v169, v9, v169
    v_mul_f32 v170, v9, v170
    v_mul_f32 v171, v9, v171
    v_mul_f32 v172, v9, v172
    v_mul_f32 v173, v9, v173
    v_mul_f32 v174, v9, v174
    v_mul_f32 v175, v9, v175
    v_mul_f32 v176, v9, v176
    v_mul_f32 v177, v9, v177
    v_mul_f32 v178, v9, v178
    v_mul_f32 v179, v9, v179
    v_mul_f32 v180, v9, v180
    v_mul_f32 v181, v9, v181
    v_mul_f32 v182, v9, v182
    v_mul_f32 v183, v9, v183
    v_mul_f32 v184, v9, v184
    v_mul_f32 v185, v9, v185
    v_mul_f32 v186, v9, v186
    v_mul_f32 v187, v9, v187
    v_mul_f32 v188, v9, v188
    v_mul_f32 v189, v9, v189
    v_mul_f32 v190, v9, v190
    v_mul_f32 v191, v9, v191
    v_mul_f32 v192, v9, v192
    v_mul_f32 v193, v9, v193
    v_mul_f32 v194, v9, v194
    v_mul_f32 v195, v9, v195
    v_mul_f32 v196, v9, v196
    v_mul_f32 v197, v9, v197
    v_mul_f32 v198, v9, v198
    v_mul_f32 v199, v9, v199
    v_mul_f32 v200, v9, v200
    v_mul_f32 v201, v9, v201
    v_mul_f32 v202, v9, v202
    v_mul_f32 v203, v9, v203
    v_mul_f32 v204, v9, v204
    v_mul_f32 v205, v9, v205
    v_mul_f32 v206, v9, v206
    v_mul_f32 v207, v9, v207
    v_mul_f32 v208, v9, v208
    v_mul_f32 v209, v9, v209
    v_mul_f32 v210, v9, v210
    v_mul_f32 v211, v9, v211
    v_mul_f32 v212, v9, v212
    v_mul_f32 v213, v9, v213
    v_mul_f32 v214, v9, v214
    v_mul_f32 v215, v9, v215
    v_mul_f32 v216, v9, v216
    v_mul_f32 v217, v9, v217
    v_mul_f32 v218, v9, v218
    v_mul_f32 v219, v9, v219
    v_mul_f32 v220, v9, v220
    v_mul_f32 v221, v9, v221
    v_mul_f32 v222, v9, v222
    v_mul_f32 v223, v9, v223
    v_mul_f32 v224, v9, v224
    v_mul_f32 v225, v9, v225
    v_mul_f32 v226, v9, v226
    v_mul_f32 v227, v9, v227
    v_mul_f32 v228, v9, v228
    v_mul_f32 v229, v9, v229
    v_mul_f32 v230, v9, v230
    v_mul_f32 v231, v9, v231
    v_mul_f32 v232, v9, v232
    v_mul_f32 v233, v9, v233
    v_mul_f32 v234, v9, v234
    v_mul_f32 v235, v9, v235
    v_mul_f32 v236, v9, v236
    v_mul_f32 v237, v9, v237
    v_mul_f32 v238, v9, v238
    v_mul_f32 v239, v9, v239
    v_mul_f32 v240, v9, v240
    v_mul_f32 v241, v9, v241
    v_mul_f32 v242, v9, v242
    v_mul_f32 v243, v9, v243
    v_mul_f32 v244, v9, v244
    v_mul_f32 v245, v9, v245
    v_mul_f32 v246, v9, v246
    v_mul_f32 v247, v9, v247
    v_mul_f32 v248, v9, v248
    v_mul_f32 v249, v9, v249
    v_mul_f32 v250, v9, v250
    v_mul_f32 v251, v9, v251
    v_mul_f32 v252, v9, v252
    v_mul_f32 v253, v9, v253
    v_mul_f32 v254, v9, v254
    v_mul_f32 v255, v9, v255
L_nors_0:
    ds_read_b128 v[40:43], v22 offset:49408
    s_waitcnt lgkmcnt(7)
    v_mfma_f32_32x32x16_bf16 v[88:103], v[44:47], a[12:15], v[88:103]
    v_fma_f32 v72, v72, s42, -v8
    v_fma_f32 v73, v73, s42, -v8
    v_exp_f32 v72, v72
    v_exp_f32 v73, v73
    ds_read_b128 v[44:47], v23 offset:49408
    s_waitcnt lgkmcnt(7)
    v_mfma_f32_32x32x16_bf16 v[88:103], v[48:51], a[16:19], v[88:103]
    v_fma_f32 v74, v74, s42, -v8
    v_fma_f32 v75, v75, s42, -v8
    v_exp_f32 v74, v74
    v_exp_f32 v75, v75
    ds_read_b128 v[48:51], v24 offset:49408
    s_waitcnt lgkmcnt(7)
    v_mfma_f32_32x32x16_bf16 v[88:103], v[52:55], a[20:23], v[88:103]
    v_fma_f32 v76, v76, s42, -v8
    v_fma_f32 v77, v77, s42, -v8
    v_exp_f32 v76, v76
    v_exp_f32 v77, v77
    ds_read_b128 v[52:55], v25 offset:49408
    s_waitcnt lgkmcnt(7)
    v_mfma_f32_32x32x16_bf16 v[88:103], v[56:59], a[24:27], v[88:103]
    v_fma_f32 v78, v78, s42, -v8
    v_fma_f32 v79, v79, s42, -v8
    v_exp_f32 v78, v78
    v_exp_f32 v79, v79
    ds_read_b128 v[56:59], v26 offset:49408
    s_waitcnt lgkmcnt(7)
    v_mfma_f32_32x32x16_bf16 v[88:103], v[60:63], a[28:31], v[88:103]
    v_fma_f32 v80, v80, s42, -v8
    v_fma_f32 v81, v81, s42, -v8
    v_exp_f32 v80, v80
    v_exp_f32 v81, v81
    ds_read_b128 v[60:63], v27 offset:49408
    s_waitcnt lgkmcnt(7)
    v_mfma_f32_32x32x16_bf16 v[88:103], v[32:35], a[32:35], v[88:103]
    v_fma_f32 v82, v82, s42, -v8
    v_fma_f32 v83, v83, s42, -v8
    v_exp_f32 v82, v82
    v_exp_f32 v83, v83
    s_waitcnt lgkmcnt(6)
    v_mfma_f32_32x32x16_bf16 v[88:103], v[36:39], a[36:39], v[88:103]
    v_fma_f32 v84, v84, s42, -v8
    v_fma_f32 v85, v85, s42, -v8
    v_exp_f32 v84, v84
    v_exp_f32 v85, v85
    s_waitcnt lgkmcnt(5)
    v_mfma_f32_32x32x16_bf16 v[88:103], v[40:43], a[40:43], v[88:103]
    v_fma_f32 v86, v86, s42, -v8
    v_fma_f32 v87, v87, s42, -v8
    v_exp_f32 v86, v86
    v_exp_f32 v87, v87
    s_waitcnt lgkmcnt(4)
    v_mfma_f32_32x32x16_bf16 v[88:103], v[44:47], a[44:47], v[88:103]
    v_add_f32 v2, v72, v73
    v_add_f32 v3, v74, v75
    v_add_f32 v4, v76, v77
    v_add_f32 v5, v78, v79
    v_add_f32 v2, v2, v3
    v_add_f32 v4, v4, v5
    v_add_f32 v7, v7, v2
    v_add_f32 v7, v7, v4
    s_waitcnt lgkmcnt(3)
    v_mfma_f32_32x32x16_bf16 v[88:103], v[48:51], a[48:51], v[88:103]
    v_add_f32 v2, v80, v81
    v_add_f32 v3, v82, v83
    v_add_f32 v4, v84, v85
    v_add_f32 v5, v86, v87
    v_add_f32 v2, v2, v3
    v_add_f32 v4, v4, v5
    v_add_f32 v7, v7, v2
    v_add_f32 v7, v7, v4
    s_waitcnt lgkmcnt(2)
    v_mfma_f32_32x32x16_bf16 v[88:103], v[52:55], a[52:55], v[88:103]
    v_cvt_pk_bf16_f32 v64, v72, v73
    v_cvt_pk_bf16_f32 v65, v74, v75
    v_cvt_pk_bf16_f32 v66, v76, v77
    v_cvt_pk_bf16_f32 v67, v78, v79
    s_waitcnt lgkmcnt(1)
    v_mfma_f32_32x32x16_bf16 v[88:103], v[56:59], a[56:59], v[88:103]
    v_cvt_pk_bf16_f32 v68, v80, v81
    v_cvt_pk_bf16_f32 v69, v82, v83
    v_cvt_pk_bf16_f32 v70, v84, v85
    v_cvt_pk_bf16_f32 v71, v86, v87
    s_waitcnt lgkmcnt(0)
    v_mfma_f32_32x32x16_bf16 v[88:103], v[60:63], a[60:63], v[88:103]
    s_nop 1
    ds_read_b64_tr_b16 v[104:105], v28 offset:32768
    ds_read_b64_tr_b16 v[106:107], v28 offset:36864
    ds_read_b64_tr_b16 v[108:109], v29 offset:32768
    ds_read_b64_tr_b16 v[110:111], v29 offset:36864
    ds_read_b64_tr_b16 v[112:113], v30 offset:32768
    ds_read_b64_tr_b16 v[114:115], v30 offset:36864
    ds_read_b64_tr_b16 v[116:117], v31 offset:32768
    ds_read_b64_tr_b16 v[118:119], v31 offset:36864
    ds_read_b64_tr_b16 v[120:121], v28 offset:33024
    ds_read_b64_tr_b16 v[122:123], v28 offset:37120
    ds_read_b64_tr_b16 v[124:125], v29 offset:33024
    ds_read_b64_tr_b16 v[126:127], v29 offset:37120
    s_waitcnt lgkmcnt(10)
    v_mfma_f32_32x32x16_bf16 v[128:143], v[104:107], v[64:67], v[128:143]
    ds_read_b64_tr_b16 v[104:105], v30 offset:33024
    ds_read_b64_tr_b16 v[106:107], v30 offset:37120
    s_waitcnt lgkmcnt(10)
    v_mfma_f32_32x32x16_bf16 v[144:159], v[108:111], v[64:67], v[144:159]
    ds_read_b64_tr_b16 v[108:109], v31 offset:33024
    ds_read_b64_tr_b16 v[110:111], v31 offset:37120
    s_waitcnt lgkmcnt(10)
    v_mfma_f32_32x32x16_bf16 v[160:175], v[112:115], v[64:67], v[160:175]
    ds_read_b64_tr_b16 v[112:113], v28 offset:40960
    ds_read_b64_tr_b16 v[114:115], v28 offset:45056
    s_waitcnt lgkmcnt(10)
    v_mfma_f32_32x32x16_bf16 v[176:191], v[116:119], v[64:67], v[176:191]
    ds_read_b64_tr_b16 v[116:117], v29 offset:40960
    ds_read_b64_tr_b16 v[118:119], v29 offset:45056
    s_waitcnt lgkmcnt(10)
    v_mfma_f32_32x32x16_bf16 v[192:207], v[120:123], v[64:67], v[192:207]
    ds_read_b64_tr_b16 v[120:121], v30 offset:40960
    ds_read_b64_tr_b16 v[122:123], v30 offset:45056
    s_waitcnt lgkmcnt(10)
    v_mfma_f32_32x32x16_bf16 v[208:223], v[124:127], v[64:67], v[208:223]
    ds_read_b64_tr_b16 v[124:125], v31 offset:40960
    ds_read_b64_tr_b16 v[126:127], v31 offset:45056
    s_waitcnt lgkmcnt(10)
    v_mfma_f32_32x32x16_bf16 v[224:239], v[104:107], v[64:67], v[224:239]
    ds_read_b64_tr_b16 v[104:105], v28 offset:41216
    ds_read_b64_tr_b16 v[106:107], v28 offset:45312
    s_waitcnt lgkmcnt(10)
    v_mfma_f32_32x32x16_bf16 v[240:255], v[108:111], v[64:67], v[240:255]
    ds_read_b64_tr_b16 v[108:109], v29 offset:41216
    ds_read_b64_tr_b16 v[110:111], v29 offset:45312
    s_waitcnt lgkmcnt(10)
    v_mfma_f32_32x32x16_bf16 v[128:143], v[112:115], v[68:71], v[128:143]
    ds_read_b64_tr_b16 v[112:113], v30 offset:41216
    ds_read_b64_tr_b16 v[114:115], v30 offset:45312
    s_waitcnt lgkmcnt(10)
    v_mfma_f32_32x32x16_bf16 v[144:159], v[116:119], v[68:71], v[144:159]
    ds_read_b64_tr_b16 v[116:117], v31 offset:41216
    ds_read_b64_tr_b16 v[118:119], v31 offset:45312
    s_waitcnt lgkmcnt(10)
    v_mfma_f32_32x32x16_bf16 v[160:175], v[120:123], v[68:71], v[160:175]
    s_waitcnt lgkmcnt(8)
    v_mfma_f32_32x32x16_bf16 v[176:191], v[124:127], v[68:71], v[176:191]
    s_waitcnt lgkmcnt(6)
    v_mfma_f32_32x32x16_bf16 v[192:207], v[104:107], v[68:71], v[192:207]
    s_waitcnt lgkmcnt(4)
    v_mfma_f32_32x32x16_bf16 v[208:223], v[108:111], v[68:71], v[208:223]
    s_waitcnt lgkmcnt(2)
    v_mfma_f32_32x32x16_bf16 v[224:239], v[112:115], v[68:71], v[224:239]
    s_waitcnt lgkmcnt(0)
    v_mfma_f32_32x32x16_bf16 v[240:255], v[116:119], v[68:71], v[240:255]
    s_waitcnt vmcnt(8) lgkmcnt(0)
    s_barrier
    s_add_u32 s45, s46, 32768
    s_mov_b32 m0, s45
    s_nop 0
    buffer_load_dwordx4 v12, s[12:15], s43 offen offset:0 lds
    buffer_load_dwordx4 v13, s[12:15], s43 offen offset:1024 lds
    buffer_load_dwordx4 v14, s[12:15], s43 offen offset:2048 lds
    buffer_load_dwordx4 v15, s[12:15], s43 offen offset:3072 lds
    s_add_u32 s45, s46, 98304
    s_mov_b32 m0, s45
    s_nop 0
    buffer_load_dwordx4 v16, s[16:19], s43 offen offset:0 lds
    buffer_load_dwordx4 v17, s[16:19], s43 offen offset:1024 lds
    buffer_load_dwordx4 v16, s[16:19], s43 offen offset:2048 lds
    buffer_load_dwordx4 v17, s[16:19], s43 offen offset:3072 lds
    s_add_u32 s43, s43, 16384
    ds_read_b128 v[32:35], v20 offset:0
    ds_read_b128 v[36:39], v21 offset:0
    ds_read_b128 v[40:43], v22 offset:0
    ds_read_b128 v[44:47], v23 offset:0
    ds_read_b128 v[48:51], v24 offset:0
    ds_read_b128 v[52:55], v25 offset:0
    ds_read_b128 v[56:59], v26 offset:0
    ds_read_b128 v[60:63], v27 offset:0
    s_waitcnt lgkmcnt(7)
    v_mfma_f32_32x32x16_bf16 v[72:87], v[32:35], a[0:3], 0
    v_max3_f32 v2, v88, v89, v90
    v_max3_f32 v3, v91, v92, v93
    v_max3_f32 v4, v94, v95, v96
    v_max3_f32 v5, v97, v98, v99
    v_max3_f32 v2, v2, v100, v101
    ds_read_b128 v[32:35], v20 offset:256
    s_waitcnt lgkmcnt(7)
    v_mfma_f32_32x32x16_bf16 v[72:87], v[36:39], a[4:7], v[72:87]
    v_max3_f32 v3, v3, v102, v103
    v_max3_f32 v2, v2, v3, v4
    v_max_f32 v2, v2, v5
    v_mov_b32 v3, v2
    ds_read_b128 v[36:39], v21 offset:256
    s_waitcnt lgkmcnt(7)
    v_mfma_f32_32x32x16_bf16 v[72:87], v[40:43], a[8:11], v[72:87]
    v_permlane32_swap_b32 v2, v3
    s_nop 1
    v_max_f32 v2, v2, v3
    v_add_f32 v3, s50, v6
    v_cmp_gt_f32 vcc, v2, v3
    s_nop 3
    s_cbranch_vccz L_nors_1
    v_max_f32 v2, v2, v6
    v_sub_f32 v3, v6, v2
    v_mul_f32 v3, s42, v3
    v_exp_f32 v9, v3
    v_mov_b32 v6, v2
    v_mul_f32 v8, s42, v2
    v_mul_f32 v7, v7, v9
    v_mul_f32 v128, v9, v128
    v_mul_f32 v129, v9, v129
    v_mul_f32 v130, v9, v130
    v_mul_f32 v131, v9, v131
    v_mul_f32 v132, v9, v132
    v_mul_f32 v133, v9, v133
    v_mul_f32 v134, v9, v134
    v_mul_f32 v135, v9, v135
    v_mul_f32 v136, v9, v136
    v_mul_f32 v137, v9, v137
    v_mul_f32 v138, v9, v138
    v_mul_f32 v139, v9, v139
    v_mul_f32 v140, v9, v140
    v_mul_f32 v141, v9, v141
    v_mul_f32 v142, v9, v142
    v_mul_f32 v143, v9, v143
    v_mul_f32 v144, v9, v144
    v_mul_f32 v145, v9, v145
    v_mul_f32 v146, v9, v146
    v_mul_f32 v147, v9, v147
    v_mul_f32 v148, v9, v148
    v_mul_f32 v149, v9, v149
    v_mul_f32 v150, v9, v150
    v_mul_f32 v151, v9, v151
    v_mul_f32 v152, v9, v152
    v_mul_f32 v153, v9, v153
    v_mul_f32 v154, v9, v154
    v_mul_f32 v155, v9, v155
    v_mul_f32 v156, v9, v156
    v_mul_f32 v157, v9, v157
    v_mul_f32 v158, v9, v158
    v_mul_f32 v159, v9, v159
    v_mul_f32 v160, v9, v160
    v_mul_f32 v161, v9, v161
    v_mul_f32 v162, v9, v162
    v_mul_f32 v163, v9, v163
    v_mul_f32 v164, v9, v164
    v_mul_f32 v165, v9, v165
    v_mul_f32 v166, v9, v166
    v_mul_f32 v167, v9, v167
    v_mul_f32 v168, v9, v168
    v_mul_f32 v169, v9, v169
    v_mul_f32 v170, v9, v170
    v_mul_f32 v171, v9, v171
    v_mul_f32 v172, v9, v172
    v_mul_f32 v173, v9, v173
    v_mul_f32 v174, v9, v174
    v_mul_f32 v175, v9, v175
    v_mul_f32 v176, v9, v176
    v_mul_f32 v177, v9, v177
    v_mul_f32 v178, v9, v178
    v_mul_f32 v179, v9, v179
    v_mul_f32 v180, v9, v180
    v_mul_f32 v181, v9, v181
    v_mul_f32 v182, v9, v182
    v_mul_f32 v183, v9, v183
    v_mul_f32 v184, v9, v184
    v_mul_f32 v185, v9, v185
    v_mul_f32 v186, v9, v186
    v_mul_f32 v187, v9, v187
    v_mul_f32 v188, v9, v188
    v_mul_f32 v189, v9, v189
    v_mul_f32 v190, v9, v190
    v_mul_f32 v191, v9, v191
    v_mul_f32 v192, v9, v192
    v_mul_f32 v193, v9, v193
    v_mul_f32 v194, v9, v194
    v_mul_f32 v195, v9, v195
    v_mul_f32 v196, v9, v196
    v_mul_f32 v197, v9, v197
    v_mul_f32 v198, v9, v198
    v_mul_f32 v199, v9, v199
    v_mul_f32 v200, v9, v200
    v_mul_f32 v201, v9, v201
    v_mul_f32 v202, v9, v202
    v_mul_f32 v203, v9, v203
    v_mul_f32 v204, v9, v204
    v_mul_f32 v205, v9, v205
    v_mul_f32 v206, v9, v206
    v_mul_f32 v207, v9, v207
    v_mul_f32 v208, v9, v208
    v_mul_f32 v209, v9, v209
    v_mul_f32 v210, v9, v210
    v_mul_f32 v211, v9, v211
    v_mul_f32 v212, v9, v212
    v_mul_f32 v213, v9, v213
    v_mul_f32 v214, v9, v214
    v_mul_f32 v215, v9, v215
    v_mul_f32 v216, v9, v216
    v_mul_f32 v217, v9, v217
    v_mul_f32 v218, v9, v218
    v_mul_f32 v219, v9, v219
    v_mul_f32 v220, v9, v220
    v_mul_f32 v221, v9, v221
    v_mul_f32 v222, v9, v222
    v_mul_f32 v223, v9, v223
    v_mul_f32 v224, v9, v224
    v_mul_f32 v225, v9, v225
    v_mul_f32 v226, v9, v226
    v_mul_f32 v227, v9, v227
    v_mul_f32 v228, v9, v228
    v_mul_f32 v229, v9, v229
    v_mul_f32 v230, v9, v230
    v_mul_f32 v231, v9, v231
    v_mul_f32 v232, v9, v232
    v_mul_f32 v233, v9, v233
    v_mul_f32 v234, v9, v234
    v_mul_f32 v235, v9, v235
    v_mul_f32 v236, v9, v236
    v_mul_f32 v237, v9, v237
    v_mul_f32 v238, v9, v238
    v_mul_f32 v239, v9, v239
    v_mul_f32 v240, v9, v240
    v_mul_f32 v241, v9, v241
    v_mul_f32 v242, v9, v242
    v_mul_f32 v243, v9, v243
    v_mul_f32 v244, v9, v244
    v_mul_f32 v245, v9, v245
    v_mul_f32 v246, v9, v246
    v_mul_f32 v247, v9, v247
    v_mul_f32 v248, v9, v248
    v_mul_f32 v249, v9, v249
    v_mul_f32 v250, v9, v250
    v_mul_f32 v251, v9, v251
    v_mul_f32 v252, v9, v252
    v_mul_f32 v253, v9, v253
    v_mul_f32 v254, v9, v254
    v_mul_f32 v255, v9, v255
L_nors_1:
    ds_read_b128 v[40:43], v22 offset:256
    s_waitcnt lgkmcnt(7)
    v_mfma_f32_32x32x16_bf16 v[72:87], v[44:47], a[12:15], v[72:87]
    v_fma_f32 v88, v88, s42, -v8
    v_fma_f32 v89, v89, s42, -v8
    v_exp_f32 v88, v88
    v_exp_f32 v89, v89
    ds_read_b128 v[44:47], v23 offset:256
    s_waitcnt lgkmcnt(7)
    v_mfma_f32_32x32x16_bf16 v[72:87], v[48:51], a[16:19], v[72:87]
    v_fma_f32 v90, v90, s42, -v8
    v_fma_f32 v91, v91, s42, -v8
    v_exp_f32 v90, v90
    v_exp_f32 v91, v91
    ds_read_b128 v[48:51], v24 offset:256
    s_waitcnt lgkmcnt(7)
    v_mfma_f32_32x32x16_bf16 v[72:87], v[52:55], a[20:23], v[72:87]
    v_fma_f32 v92, v92, s42, -v8
    v_fma_f32 v93, v93, s42, -v8
    v_exp_f32 v92, v92
    v_exp_f32 v93, v93
    ds_read_b128 v[52:55], v25 offset:256
    s_waitcnt lgkmcnt(7)
    v_mfma_f32_32x32x16_bf16 v[72:87], v[56:59], a[24:27], v[72:87]
    v_fma_f32 v94, v94, s42, -v8
    v_fma_f32 v95, v95, s42, -v8
    v_exp_f32 v94, v94
    v_exp_f32 v95, v95
    ds_read_b128 v[56:59], v26 offset:256
    s_waitcnt lgkmcnt(7)
    v_mfma_f32_32x32x16_bf16 v[72:87], v[60:63], a[28:31], v[72:87]
    v_fma_f32 v96, v96, s42, -v8
    v_fma_f32 v97, v97, s42, -v8
    v_exp_f32 v96, v96
    v_exp_f32 v97, v97
    ds_read_b128 v[60:63], v27 offset:256
    s_waitcnt lgkmcnt(7)
    v_mfma_f32_32x32x16_bf16 v[72:87], v[32:35], a[32:35], v[72:87]
    v_fma_f32 v98, v98, s42, -v8
    v_fma_f32 v99, v99, s42, -v8
    v_exp_f32 v98, v98
    v_exp_f32 v99, v99
    s_waitcnt lgkmcnt(6)
    v_mfma_f32_32x32x16_bf16 v[72:87], v[36:39], a[36:39], v[72:87]
    v_fma_f32 v100, v100, s42, -v8
    v_fma_f32 v101, v101, s42, -v8
    v_exp_f32 v100, v100
    v_exp_f32 v101, v101
    s_waitcnt lgkmcnt(5)
    v_mfma_f32_32x32x16_bf16 v[72:87], v[40:43], a[40:43], v[72:87]
    v_fma_f32 v102, v102, s42, -v8
    v_fma_f32 v103, v103, s42, -v8
    v_exp_f32 v102, v102
    v_exp_f32 v103, v103
    s_waitcnt lgkmcnt(4)
    v_mfma_f32_32x32x16_bf16 v[72:87], v[44:47], a[44:47], v[72:87]
    v_add_f32 v2, v88, v89
    v_add_f32 v3, v90, v91
    v_add_f32 v4, v92, v93
    v_add_f32 v5, v94, v95
    v_add_f32 v2, v2, v3
    v_add_f32 v4, v4, v5
    v_add_f32 v7, v7, v2
    v_add_f32 v7, v7, v4
    s_waitcnt lgkmcnt(3)
    v_mfma_f32_32x32x16_bf16 v[72:87], v[48:51], a[48:51], v[72:87]
    v_add_f32 v2, v96, v97
    v_add_f32 v3, v98, v99
    v_add_f32 v4, v100, v101
    v_add_f32 v5, v102, v103
    v_add_f32 v2, v2, v3
    v_add_f32 v4, v4, v5
    v_add_f32 v7, v7, v2
    v_add_f32 v7, v7, v4
    s_waitcnt lgkmcnt(2)
    v_mfma_f32_32x32x16_bf16 v[72:87], v[52:55], a[52:55], v[72:87]
    v_cvt_pk_bf16_f32 v64, v88, v89
    v_cvt_pk_bf16_f32 v65, v90, v91
    v_cvt_pk_bf16_f32 v66, v92, v93
    v_cvt_pk_bf16_f32 v67, v94, v95
    s_waitcnt lgkmcnt(1)
    v_mfma_f32_32x32x16_bf16 v[72:87], v[56:59], a[56:59], v[72:87]
    v_cvt_pk_bf16_f32 v68, v96, v97
    v_cvt_pk_bf16_f32 v69, v98, v99
    v_cvt_pk_bf16_f32 v70, v100, v101
    v_cvt_pk_bf16_f32 v71, v102, v103
    s_waitcnt lgkmcnt(0)
    v_mfma_f32_32x32x16_bf16 v[72:87], v[60:63], a[60:63], v[72:87]
    s_nop 1
    ds_read_b64_tr_b16 v[104:105], v28 offset:49152
    ds_read_b64_tr_b16 v[106:107], v28 offset:53248
    ds_read_b64_tr_b16 v[108:109], v29 offset:49152
    ds_read_b64_tr_b16 v[110:111], v29 offset:53248
    ds_read_b64_tr_b16 v[112:113], v30 offset:49152
    ds_read_b64_tr_b16 v[114:115], v30 offset:53248
    ds_read_b64_tr_b16 v[116:117], v31 offset:49152
    ds_read_b64_tr_b16 v[118:119], v31 offset:53248
    ds_read_b64_tr_b16 v[120:121], v28 offset:49408
    ds_read_b64_tr_b16 v[122:123], v28 offset:53504
    ds_read_b64_tr_b16 v[124:125], v29 offset:49408
    ds_read_b64_tr_b16 v[126:127], v29 offset:53504
    s_waitcnt lgkmcnt(10)
    v_mfma_f32_32x32x16_bf16 v[128:143], v[104:107], v[64:67], v[128:143]
    ds_read_b64_tr_b16 v[104:105], v30 offset:49408
    ds_read_b64_tr_b16 v[106:107], v30 offset:53504
    s_waitcnt lgkmcnt(10)
    v_mfma_f32_32x32x16_bf16 v[144:159], v[108:111], v[64:67], v[144:159]
    ds_read_b64_tr_b16 v[108:109], v31 offset:49408
    ds_read_b64_tr_b16 v[110:111], v31 offset:53504
    s_waitcnt lgkmcnt(10)
    v_mfma_f32_32x32x16_bf16 v[160:175], v[112:115], v[64:67], v[160:175]
    ds_read_b64_tr_b16 v[112:113], v28 offset:57344
    ds_read_b64_tr_b16 v[114:115], v28 offset:61440
    s_waitcnt lgkmcnt(10)
    v_mfma_f32_32x32x16_bf16 v[176:191], v[116:119], v[64:67], v[176:191]
    ds_read_b64_tr_b16 v[116:117], v29 offset:57344
    ds_read_b64_tr_b16 v[118:119], v29 offset:61440
    s_waitcnt lgkmcnt(10)
    v_mfma_f32_32x32x16_bf16 v[192:207], v[120:123], v[64:67], v[192:207]
    ds_read_b64_tr_b16 v[120:121], v30 offset:57344
    ds_read_b64_tr_b16 v[122:123], v30 offset:61440
    s_waitcnt lgkmcnt(10)
    v_mfma_f32_32x32x16_bf16 v[208:223], v[124:127], v[64:67], v[208:223]
    ds_read_b64_tr_b16 v[124:125], v31 offset:57344
    ds_read_b64_tr_b16 v[126:127], v31 offset:61440
    s_waitcnt lgkmcnt(10)
    v_mfma_f32_32x32x16_bf16 v[224:239], v[104:107], v[64:67], v[224:239]
    ds_read_b64_tr_b16 v[104:105], v28 offset:57600
    ds_read_b64_tr_b16 v[106:107], v28 offset:61696
    s_waitcnt lgkmcnt(10)
    v_mfma_f32_32x32x16_bf16 v[240:255], v[108:111], v[64:67], v[240:255]
    ds_read_b64_tr_b16 v[108:109], v29 offset:57600
    ds_read_b64_tr_b16 v[110:111], v29 offset:61696
    s_waitcnt lgkmcnt(10)
    v_mfma_f32_32x32x16_bf16 v[128:143], v[112:115], v[68:71], v[128:143]
    ds_read_b64_tr_b16 v[112:113], v30 offset:57600
    ds_read_b64_tr_b16 v[114:115], v30 offset:61696
    s_waitcnt lgkmcnt(10)
    v_mfma_f32_32x32x16_bf16 v[144:159], v[116:119], v[68:71], v[144:159]
    ds_read_b64_tr_b16 v[116:117], v31 offset:57600
    ds_read_b64_tr_b16 v[118:119], v31 offset:61696
    s_waitcnt lgkmcnt(10)
    v_mfma_f32_32x32x16_bf16 v[160:175], v[120:123], v[68:71], v[160:175]
    s_waitcnt lgkmcnt(8)
    v_mfma_f32_32x32x16_bf16 v[176:191], v[124:127], v[68:71], v[176:191]
    s_waitcnt lgkmcnt(6)
    v_mfma_f32_32x32x16_bf16 v[192:207], v[104:107], v[68:71], v[192:207]
    s_waitcnt lgkmcnt(4)
    v_mfma_f32_32x32x16_bf16 v[208:223], v[108:111], v[68:71], v[208:223]
    s_waitcnt lgkmcnt(2)
    v_mfma_f32_32x32x16_bf16 v[224:239], v[112:115], v[68:71], v[224:239]
    s_waitcnt lgkmcnt(0)
    v_mfma_f32_32x32x16_bf16 v[240:255], v[116:119], v[68:71], v[240:255]
    s_waitcnt vmcnt(8) lgkmcnt(0)
    s_barrier
    s_add_u32 s45, s46, 49152
    s_mov_b32 m0, s45
    s_nop 0
    buffer_load_dwordx4 v12, s[12:15], s43 offen offset:0 lds
    buffer_load_dwordx4 v13, s[12:15], s43 offen offset:1024 lds
    buffer_load_dwordx4 v14, s[12:15], s43 offen offset:2048 lds
    buffer_load_dwordx4 v15, s[12:15], s43 offen offset:3072 lds
    s_add_u32 s45, s46, 114688
    s_mov_b32 m0, s45
    s_nop 0
    buffer_load_dwordx4 v16, s[16:19], s43 offen offset:0 lds
    buffer_load_dwordx4 v17, s[16:19], s43 offen offset:1024 lds
    buffer_load_dwordx4 v16, s[16:19], s43 offen offset:2048 lds
    buffer_load_dwordx4 v17, s[16:19], s43 offen offset:3072 lds
    s_add_u32 s43, s43, 16384
    ds_read_b128 v[32:35], v20 offset:16384
    ds_read_b128 v[36:39], v21 offset:16384
    ds_read_b128 v[40:43], v22 offset:16384
    ds_read_b128 v[44:47], v23 offset:16384
    ds_read_b128 v[48:51], v24 offset:16384
    ds_read_b128 v[52:55], v25 offset:16384
    ds_read_b128 v[56:59], v26 offset:16384
    ds_read_b128 v[60:63], v27 offset:16384
    s_waitcnt lgkmcnt(7)
    v_mfma_f32_32x32x16_bf16 v[88:103], v[32:35], a[0:3], 0
    v_max3_f32 v2, v72, v73, v74
    v_max3_f32 v3, v75, v76, v77
    v_max3_f32 v4, v78, v79, v80
    v_max3_f32 v5, v81, v82, v83
    v_max3_f32 v2, v2, v84, v85
    ds_read_b128 v[32:35], v20 offset:16640
    s_waitcnt lgkmcnt(7)
    v_mfma_f32_32x32x16_bf16 v[88:103], v[36:39], a[4:7], v[88:103]
    v_max3_f32 v3, v3, v86, v87
    v_max3_f32 v2, v2, v3, v4
    v_max_f32 v2, v2, v5
    v_mov_b32 v3, v2
    ds_read_b128 v[36:39], v21 offset:16640
    s_waitcnt lgkmcnt(7)
    v_mfma_f32_32x32x16_bf16 v[88:103], v[40:43], a[8:11], v[88:103]
    v_permlane32_swap_b32 v2, v3
    s_nop 1
    v_max_f32 v2, v2, v3
    v_add_f32 v3, s50, v6
    v_cmp_gt_f32 vcc, v2, v3
    s_nop 3
    s_cbranch_vccz L_nors_2
    v_max_f32 v2, v2, v6
    v_sub_f32 v3, v6, v2
    v_mul_f32 v3, s42, v3
    v_exp_f32 v9, v3
    v_mov_b32 v6, v2
    v_mul_f32 v8, s42, v2
    v_mul_f32 v7, v7, v9
    v_mul_f32 v128, v9, v128
    v_mul_f32 v129, v9, v129
    v_mul_f32 v130, v9, v130
    v_mul_f32 v131, v9, v131
    v_mul_f32 v132, v9, v132
    v_mul_f32 v133, v9, v133
    v_mul_f32 v134, v9, v134
    v_mul_f32 v135, v9, v135
    v_mul_f32 v136, v9, v136
    v_mul_f32 v137, v9, v137
    v_mul_f32 v138, v9, v138
    v_mul_f32 v139, v9, v139
    v_mul_f32 v140, v9, v140
    v_mul_f32 v141, v9, v141
    v_mul_f32 v142, v9, v142
    v_mul_f32 v143, v9, v143
    v_mul_f32 v144, v9, v144
    v_mul_f32 v145, v9, v145
    v_mul_f32 v146, v9, v146
    v_mul_f32 v147, v9, v147
    v_mul_f32 v148, v9, v148
    v_mul_f32 v149, v9, v149
    v_mul_f32 v150, v9, v150
    v_mul_f32 v151, v9, v151
    v_mul_f32 v152, v9, v152
    v_mul_f32 v153, v9, v153
    v_mul_f32 v154, v9, v154
    v_mul_f32 v155, v9, v155
    v_mul_f32 v156, v9, v156
    v_mul_f32 v157, v9, v157
    v_mul_f32 v158, v9, v158
    v_mul_f32 v159, v9, v159
    v_mul_f32 v160, v9, v160
    v_mul_f32 v161, v9, v161
    v_mul_f32 v162, v9, v162
    v_mul_f32 v163, v9, v163
    v_mul_f32 v164, v9, v164
    v_mul_f32 v165, v9, v165
    v_mul_f32 v166, v9, v166
    v_mul_f32 v167, v9, v167
    v_mul_f32 v168, v9, v168
    v_mul_f32 v169, v9, v169
    v_mul_f32 v170, v9, v170
    v_mul_f32 v171, v9, v171
    v_mul_f32 v172, v9, v172
    v_mul_f32 v173, v9, v173
    v_mul_f32 v174, v9, v174
    v_mul_f32 v175, v9, v175
    v_mul_f32 v176, v9, v176
    v_mul_f32 v177, v9, v177
    v_mul_f32 v178, v9, v178
    v_mul_f32 v179, v9, v179
    v_mul_f32 v180, v9, v180
    v_mul_f32 v181, v9, v181
    v_mul_f32 v182, v9, v182
    v_mul_f32 v183, v9, v183
    v_mul_f32 v184, v9, v184
    v_mul_f32 v185, v9, v185
    v_mul_f32 v186, v9, v186
    v_mul_f32 v187, v9, v187
    v_mul_f32 v188, v9, v188
    v_mul_f32 v189, v9, v189
    v_mul_f32 v190, v9, v190
    v_mul_f32 v191, v9, v191
    v_mul_f32 v192, v9, v192
    v_mul_f32 v193, v9, v193
    v_mul_f32 v194, v9, v194
    v_mul_f32 v195, v9, v195
    v_mul_f32 v196, v9, v196
    v_mul_f32 v197, v9, v197
    v_mul_f32 v198, v9, v198
    v_mul_f32 v199, v9, v199
    v_mul_f32 v200, v9, v200
    v_mul_f32 v201, v9, v201
    v_mul_f32 v202, v9, v202
    v_mul_f32 v203, v9, v203
    v_mul_f32 v204, v9, v204
    v_mul_f32 v205, v9, v205
    v_mul_f32 v206, v9, v206
    v_mul_f32 v207, v9, v207
    v_mul_f32 v208, v9, v208
    v_mul_f32 v209, v9, v209
    v_mul_f32 v210, v9, v210
    v_mul_f32 v211, v9, v211
    v_mul_f32 v212, v9, v212
    v_mul_f32 v213, v9, v213
    v_mul_f32 v214, v9, v214
    v_mul_f32 v215, v9, v215
    v_mul_f32 v216, v9, v216
    v_mul_f32 v217, v9, v217
    v_mul_f32 v218, v9, v218
    v_mul_f32 v219, v9, v219
    v_mul_f32 v220, v9, v220
    v_mul_f32 v221, v9, v221
    v_mul_f32 v222, v9, v222
    v_mul_f32 v223, v9, v223
    v_mul_f32 v224, v9, v224
    v_mul_f32 v225, v9, v225
    v_mul_f32 v226, v9, v226
    v_mul_f32 v227, v9, v227
    v_mul_f32 v228, v9, v228
    v_mul_f32 v229, v9, v229
    v_mul_f32 v230, v9, v230
    v_mul_f32 v231, v9, v231
    v_mul_f32 v232, v9, v232
    v_mul_f32 v233, v9, v233
    v_mul_f32 v234, v9, v234
    v_mul_f32 v235, v9, v235
    v_mul_f32 v236, v9, v236
    v_mul_f32 v237, v9, v237
    v_mul_f32 v238, v9, v238
    v_mul_f32 v239, v9, v239
    v_mul_f32 v240, v9, v240
    v_mul_f32 v241, v9, v241
    v_mul_f32 v242, v9, v242
    v_mul_f32 v243, v9, v243
    v_mul_f32 v244, v9, v244
    v_mul_f32 v245, v9, v245
    v_mul_f32 v246, v9, v246
    v_mul_f32 v247, v9, v247
    v_mul_f32 v248, v9, v248
    v_mul_f32 v249, v9, v249
    v_mul_f32 v250, v9, v250
    v_mul_f32 v251, v9, v251
    v_mul_f32 v252, v9, v252
    v_mul_f32 v253, v9, v253
    v_mul_f32 v254, v9, v254
    v_mul_f32 v255, v9, v255
L_nors_2:
    ds_read_b128 v[40:43], v22 offset:16640
    s_waitcnt lgkmcnt(7)
    v_mfma_f32_32x32x16_bf16 v[88:103], v[44:47], a[12:15], v[88:103]
    v_fma_f32 v72, v72, s42, -v8
    v_fma_f32 v73, v73, s42, -v8
    v_exp_f32 v72, v72
    v_exp_f32 v73, v73
    ds_read_b128 v[44:47], v23 offset:16640
    s_waitcnt lgkmcnt(7)
    v_mfma_f32_32x32x16_bf16 v[88:103], v[48:51], a[16:19], v[88:103]
    v_fma_f32 v74, v74, s42, -v8
    v_fma_f32 v75, v75, s42, -v8
    v_exp_f32 v74, v74
    v_exp_f32 v75, v75
    ds_read_b128 v[48:51], v24 offset:16640
    s_waitcnt lgkmcnt(7)
    v_mfma_f32_32x32x16_bf16 v[88:103], v[52:55], a[20:23], v[88:103]
    v_fma_f32 v76, v76, s42, -v8
    v_fma_f32 v77, v77, s42, -v8
    v_exp_f32 v76, v76
    v_exp_f32 v77, v77
    ds_read_b128 v[52:55], v25 offset:16640
    s_waitcnt lgkmcnt(7)
    v_mfma_f32_32x32x16_bf16 v[88:103], v[56:59], a[24:27], v[88:103]
    v_fma_f32 v78, v78, s42, -v8
    v_fma_f32 v79, v79, s42, -v8
    v_exp_f32 v78, v78
    v_exp_f32 v79, v79
    ds_read_b128 v[56:59], v26 offset:16640
    s_waitcnt lgkmcnt(7)
    v_mfma_f32_32x32x16_bf16 v[88:103], v[60:63], a[28:31], v[88:103]
    v_fma_f32 v80, v80, s42, -v8
    v_fma_f32 v81, v81, s42, -v8
    v_exp_f32 v80, v80
    v_exp_f32 v81, v81
    ds_read_b128 v[60:63], v27 offset:16640
    s_waitcnt lgkmcnt(7)
    v_mfma_f32_32x32x16_bf16 v[88:103], v[32:35], a[32:35], v[88:103]
    v_fma_f32 v82, v82, s42, -v8
    v_fma_f32 v83, v83, s42, -v8
    v_exp_f32 v82, v82
    v_exp_f32 v83, v83
    s_waitcnt lgkmcnt(6)
    v_mfma_f32_32x32x16_bf16 v[88:103], v[36:39], a[36:39], v[88:103]
    v_fma_f32 v84, v84, s42, -v8
    v_fma_f32 v85, v85, s42, -v8
    v_exp_f32 v84, v84
    v_exp_f32 v85, v85
    s_waitcnt lgkmcnt(5)
    v_mfma_f32_32x32x16_bf16 v[88:103], v[40:43], a[40:43], v[88:103]
    v_fma_f32 v86, v86, s42, -v8
    v_fma_f32 v87, v87, s42, -v8
    v_exp_f32 v86, v86
    v_exp_f32 v87, v87
    s_waitcnt lgkmcnt(4)
    v_mfma_f32_32x32x16_bf16 v[88:103], v[44:47], a[44:47], v[88:103]
    v_add_f32 v2, v72, v73
    v_add_f32 v3, v74, v75
    v_add_f32 v4, v76, v77
    v_add_f32 v5, v78, v79
    v_add_f32 v2, v2, v3
    v_add_f32 v4, v4, v5
    v_add_f32 v7, v7, v2
    v_add_f32 v7, v7, v4
    s_waitcnt lgkmcnt(3)
    v_mfma_f32_32x32x16_bf16 v[88:103], v[48:51], a[48:51], v[88:103]
    v_add_f32 v2, v80, v81
    v_add_f32 v3, v82, v83
    v_add_f32 v4, v84, v85
    v_add_f32 v5, v86, v87
    v_add_f32 v2, v2, v3
    v_add_f32 v4, v4, v5
    v_add_f32 v7, v7, v2
    v_add_f32 v7, v7, v4
    s_waitcnt lgkmcnt(2)
    v_mfma_f32_32x32x16_bf16 v[88:103], v[52:55], a[52:55], v[88:103]
    v_cvt_pk_bf16_f32 v64, v72, v73
    v_cvt_pk_bf16_f32 v65, v74, v75
    v_cvt_pk_bf16_f32 v66, v76, v77
    v_cvt_pk_bf16_f32 v67, v78, v79
    s_waitcnt lgkmcnt(1)
    v_mfma_f32_32x32x16_bf16 v[88:103], v[56:59], a[56:59], v[88:103]
    v_cvt_pk_bf16_f32 v68, v80, v81
    v_cvt_pk_bf16_f32 v69, v82, v83
    v_cvt_pk_bf16_f32 v70, v84, v85
    v_cvt_pk_bf16_f32 v71, v86, v87
    s_waitcnt lgkmcnt(0)
    v_mfma_f32_32x32x16_bf16 v[88:103], v[60:63], a[60:63], v[88:103]
    s_nop 1
    ds_read_b64_tr_b16 v[104:105], v28 offset:0
    ds_read_b64_tr_b16 v[106:107], v28 offset:4096
    ds_read_b64_tr_b16 v[108:109], v29 offset:0
    ds_read_b64_tr_b16 v[110:111], v29 offset:4096
    ds_read_b64_tr_b16 v[112:113], v30 offset:0
    ds_read_b64_tr_b16 v[114:115], v30 offset:4096
    ds_read_b64_tr_b16 v[116:117], v31 offset:0
    ds_read_b64_tr_b16 v[118:119], v31 offset:4096
    ds_read_b64_tr_b16 v[120:121], v28 offset:256
    ds_read_b64_tr_b16 v[122:123], v28 offset:4352
    ds_read_b64_tr_b16 v[124:125], v29 offset:256
    ds_read_b64_tr_b16 v[126:127], v29 offset:4352
    s_waitcnt lgkmcnt(10)
    v_mfma_f32_32x32x16_bf16 v[128:143], v[104:107], v[64:67], v[128:143]
    ds_read_b64_tr_b16 v[104:105], v30 offset:256
    ds_read_b64_tr_b16 v[106:107], v30 offset:4352
    s_waitcnt lgkmcnt(10)
    v_mfma_f32_32x32x16_bf16 v[144:159], v[108:111], v[64:67], v[144:159]
    ds_read_b64_tr_b16 v[108:109], v31 offset:256
    ds_read_b64_tr_b16 v[110:111], v31 offset:4352
    s_waitcnt lgkmcnt(10)
    v_mfma_f32_32x32x16_bf16 v[160:175], v[112:115], v[64:67], v[160:175]
    ds_read_b64_tr_b16 v[112:113], v28 offset:8192
    ds_read_b64_tr_b16 v[114:115], v28 offset:12288
    s_waitcnt lgkmcnt(10)
    v_mfma_f32_32x32x16_bf16 v[176:191], v[116:119], v[64:67], v[176:191]
    ds_read_b64_tr_b16 v[116:117], v29 offset:8192
    ds_read_b64_tr_b16 v[118:119], v29 offset:12288
    s_waitcnt lgkmcnt(10)
    v_mfma_f32_32x32x16_bf16 v[192:207], v[120:123], v[64:67], v[192:207]
    ds_read_b64_tr_b16 v[120:121], v30 offset:8192
    ds_read_b64_tr_b16 v[122:123], v30 offset:12288
    s_waitcnt lgkmcnt(10)
    v_mfma_f32_32x32x16_bf16 v[208:223], v[124:127], v[64:67], v[208:223]
    ds_read_b64_tr_b16 v[124:125], v31 offset:8192
    ds_read_b64_tr_b16 v[126:127], v31 offset:12288
    s_waitcnt lgkmcnt(10)
    v_mfma_f32_32x32x16_bf16 v[224:239], v[104:107], v[64:67], v[224:239]
    ds_read_b64_tr_b16 v[104:105], v28 offset:8448
    ds_read_b64_tr_b16 v[106:107], v28 offset:12544
    s_waitcnt lgkmcnt(10)
    v_mfma_f32_32x32x16_bf16 v[240:255], v[108:111], v[64:67], v[240:255]
    ds_read_b64_tr_b16 v[108:109], v29 offset:8448
    ds_read_b64_tr_b16 v[110:111], v29 offset:12544
    s_waitcnt lgkmcnt(10)
    v_mfma_f32_32x32x16_bf16 v[128:143], v[112:115], v[68:71], v[128:143]
    ds_read_b64_tr_b16 v[112:113], v30 offset:8448
    ds_read_b64_tr_b16 v[114:115], v30 offset:12544
    s_waitcnt lgkmcnt(10)
    v_mfma_f32_32x32x16_bf16 v[144:159], v[116:119], v[68:71], v[144:159]
    ds_read_b64_tr_b16 v[116:117], v31 offset:8448
    ds_read_b64_tr_b16 v[118:119], v31 offset:12544
    s_waitcnt lgkmcnt(10)
    v_mfma_f32_32x32x16_bf16 v[160:175], v[120:123], v[68:71], v[160:175]
    s_waitcnt lgkmcnt(8)
    v_mfma_f32_32x32x16_bf16 v[176:191], v[124:127], v[68:71], v[176:191]
    s_waitcnt lgkmcnt(6)
    v_mfma_f32_32x32x16_bf16 v[192:207], v[104:107], v[68:71], v[192:207]
    s_waitcnt lgkmcnt(4)
    v_mfma_f32_32x32x16_bf16 v[208:223], v[108:111], v[68:71], v[208:223]
    s_waitcnt lgkmcnt(2)
    v_mfma_f32_32x32x16_bf16 v[224:239], v[112:115], v[68:71], v[224:239]
    s_waitcnt lgkmcnt(0)
    v_mfma_f32_32x32x16_bf16 v[240:255], v[116:119], v[68:71], v[240:255]
    s_waitcnt vmcnt(8) lgkmcnt(0)
    s_barrier
    s_add_u32 s45, s46, 0
    s_mov_b32 m0, s45
    s_nop 0
    buffer_load_dwordx4 v12, s[12:15], s43 offen offset:0 lds
    buffer_load_dwordx4 v13, s[12:15], s43 offen offset:1024 lds
    buffer_load_dwordx4 v14, s[12:15], s43 offen offset:2048 lds
    buffer_load_dwordx4 v15, s[12:15], s43 offen offset:3072 lds
    s_add_u32 s45, s46, 65536
    s_mov_b32 m0, s45
    s_nop 0
    buffer_load_dwordx4 v16, s[16:19], s43 offen offset:0 lds
    buffer_load_dwordx4 v17, s[16:19], s43 offen offset:1024 lds
    buffer_load_dwordx4 v16, s[16:19], s43 offen offset:2048 lds
    buffer_load_dwordx4 v17, s[16:19], s43 offen offset:3072 lds
    s_add_u32 s43, s43, 16384
    ds_read_b128 v[32:35], v20 offset:32768
    ds_read_b128 v[36:39], v21 offset:32768
    ds_read_b128 v[40:43], v22 offset:32768
    ds_read_b128 v[44:47], v23 offset:32768
    ds_read_b128 v[48:51], v24 offset:32768
    ds_read_b128 v[52:55], v25 offset:32768
    ds_read_b128 v[56:59], v26 offset:32768
    ds_read_b128 v[60:63], v27 offset:32768
    s_waitcnt lgkmcnt(7)
    v_mfma_f32_32x32x16_bf16 v[72:87], v[32:35], a[0:3], 0
    v_max3_f32 v2, v88, v89, v90
    v_max3_f32 v3, v91, v92, v93
    v_max3_f32 v4, v94, v95, v96
    v_max3_f32 v5, v97, v98, v99
    v_max3_f32 v2, v2, v100, v101
    ds_read_b128 v[32:35], v20 offset:33024
    s_waitcnt lgkmcnt(7)
    v_mfma_f32_32x32x16_bf16 v[72:87], v[36:39], a[4:7], v[72:87]
    v_max3_f32 v3, v3, v102, v103
    v_max3_f32 v2, v2, v3, v4
    v_max_f32 v2, v2, v5
    v_mov_b32 v3, v2
    ds_read_b128 v[36:39], v21 offset:33024
    s_waitcnt lgkmcnt(7)
    v_mfma_f32_32x32x16_bf16 v[72:87], v[40:43], a[8:11], v[72:87]
    v_permlane32_swap_b32 v2, v3
    s_nop 1
    v_max_f32 v2, v2, v3
    v_add_f32 v3, s50, v6
    v_cmp_gt_f32 vcc, v2, v3
    s_nop 3
    s_cbranch_vccz L_nors_3
    v_max_f32 v2, v2, v6
    v_sub_f32 v3, v6, v2
    v_mul_f32 v3, s42, v3
    v_exp_f32 v9, v3
    v_mov_b32 v6, v2
    v_mul_f32 v8, s42, v2
    v_mul_f32 v7, v7, v9
    v_mul_f32 v128, v9, v128
    v_mul_f32 v129, v9, v129
    v_mul_f32 v130, v9, v130
    v_mul_f32 v131, v9, v131
    v_mul_f32 v132, v9, v132
    v_mul_f32 v133, v9, v133
    v_mul_f32 v134, v9, v134
    v_mul_f32 v135, v9, v135
    v_mul_f32 v136, v9, v136
    v_mul_f32 v137, v9, v137
    v_mul_f32 v138, v9, v138
    v_mul_f32 v139, v9, v139
    v_mul_f32 v140, v9, v140
    v_mul_f32 v141, v9, v141
    v_mul_f32 v142, v9, v142
    v_mul_f32 v143, v9, v143
    v_mul_f32 v144, v9, v144
    v_mul_f32 v145, v9, v145
    v_mul_f32 v146, v9, v146
    v_mul_f32 v147, v9, v147
    v_mul_f32 v148, v9, v148
    v_mul_f32 v149, v9, v149
    v_mul_f32 v150, v9, v150
    v_mul_f32 v151, v9, v151
    v_mul_f32 v152, v9, v152
    v_mul_f32 v153, v9, v153
    v_mul_f32 v154, v9, v154
    v_mul_f32 v155, v9, v155
    v_mul_f32 v156, v9, v156
    v_mul_f32 v157, v9, v157
    v_mul_f32 v158, v9, v158
    v_mul_f32 v159, v9, v159
    v_mul_f32 v160, v9, v160
    v_mul_f32 v161, v9, v161
    v_mul_f32 v162, v9, v162
    v_mul_f32 v163, v9, v163
    v_mul_f32 v164, v9, v164
    v_mul_f32 v165, v9, v165
    v_mul_f32 v166, v9, v166
    v_mul_f32 v167, v9, v167
    v_mul_f32 v168, v9, v168
    v_mul_f32 v169, v9, v169
    v_mul_f32 v170, v9, v170
    v_mul_f32 v171, v9, v171
    v_mul_f32 v172, v9, v172
    v_mul_f32 v173, v9, v173
    v_mul_f32 v174, v9, v174
    v_mul_f32 v175, v9, v175
    v_mul_f32 v176, v9, v176
    v_mul_f32 v177, v9, v177
    v_mul_f32 v178, v9, v178
    v_mul_f32 v179, v9, v179
    v_mul_f32 v180, v9, v180
    v_mul_f32 v181, v9, v181
    v_mul_f32 v182, v9, v182
    v_mul_f32 v183, v9, v183
    v_mul_f32 v184, v9, v184
    v_mul_f32 v185, v9, v185
    v_mul_f32 v186, v9, v186
    v_mul_f32 v187, v9, v187
    v_mul_f32 v188, v9, v188
    v_mul_f32 v189, v9, v189
    v_mul_f32 v190, v9, v190
    v_mul_f32 v191, v9, v191
    v_mul_f32 v192, v9, v192
    v_mul_f32 v193, v9, v193
    v_mul_f32 v194, v9, v194
    v_mul_f32 v195, v9, v195
    v_mul_f32 v196, v9, v196
    v_mul_f32 v197, v9, v197
    v_mul_f32 v198, v9, v198
    v_mul_f32 v199, v9, v199
    v_mul_f32 v200, v9, v200
    v_mul_f32 v201, v9, v201
    v_mul_f32 v202, v9, v202
    v_mul_f32 v203, v9, v203
    v_mul_f32 v204, v9, v204
    v_mul_f32 v205, v9, v205
    v_mul_f32 v206, v9, v206
    v_mul_f32 v207, v9, v207
    v_mul_f32 v208, v9, v208
    v_mul_f32 v209, v9, v209
    v_mul_f32 v210, v9, v210
    v_mul_f32 v211, v9, v211
    v_mul_f32 v212, v9, v212
    v_mul_f32 v213, v9, v213
    v_mul_f32 v214, v9, v214
    v_mul_f32 v215, v9, v215
    v_mul_f32 v216, v9, v216
    v_mul_f32 v217, v9, v217
    v_mul_f32 v218, v9, v218
    v_mul_f32 v219, v9, v219
    v_mul_f32 v220, v9, v220
    v_mul_f32 v221, v9, v221
    v_mul_f32 v222, v9, v222
    v_mul_f32 v223, v9, v223
    v_mul_f32 v224, v9, v224
    v_mul_f32 v225, v9, v225
    v_mul_f32 v226, v9, v226
    v_mul_f32 v227, v9, v227
    v_mul_f32 v228, v9, v228
    v_mul_f32 v229, v9, v229
    v_mul_f32 v230, v9, v230
    v_mul_f32 v231, v9, v231
    v_mul_f32 v232, v9, v232
    v_mul_f32 v233, v9, v233
    v_mul_f32 v234, v9, v234
    v_mul_f32 v235, v9, v235
    v_mul_f32 v236, v9, v236
    v_mul_f32 v237, v9, v237
    v_mul_f32 v238, v9, v238
    v_mul_f32 v239, v9, v239
    v_mul_f32 v240, v9, v240
    v_mul_f32 v241, v9, v241
    v_mul_f32 v242, v9, v242
    v_mul_f32 v243, v9, v243
    v_mul_f32 v244, v9, v244
    v_mul_f32 v245, v9, v245
    v_mul_f32 v246, v9, v246
    v_mul_f32 v247, v9, v247
    v_mul_f32 v248, v9, v248
    v_mul_f32 v249, v9, v249
    v_mul_f32 v250, v9, v250
    v_mul_f32 v251, v9, v251
    v_mul_f32 v252, v9, v252
    v_mul_f32 v253, v9, v253
    v_mul_f32 v254, v9, v254
    v_mul_f32 v255, v9, v255
L_nors_3:
    ds_read_b128 v[40:43], v22 offset:33024
    s_waitcnt lgkmcnt(7)
    v_mfma_f32_32x32x16_bf16 v[72:87], v[44:47], a[12:15], v[72:87]
    v_fma_f32 v88, v88, s42, -v8
    v_fma_f32 v89, v89, s42, -v8
    v_exp_f32 v88, v88
    v_exp_f32 v89, v89
    ds_read_b128 v[44:47], v23 offset:33024
    s_waitcnt lgkmcnt(7)
    v_mfma_f32_32x32x16_bf16 v[72:87], v[48:51], a[16:19], v[72:87]
    v_fma_f32 v90, v90, s42, -v8
    v_fma_f32 v91, v91, s42, -v8
    v_exp_f32 v90, v90
    v_exp_f32 v91, v91
    ds_read_b128 v[48:51], v24 offset:33024
    s_waitcnt lgkmcnt(7)
    v_mfma_f32_32x32x16_bf16 v[72:87], v[52:55], a[20:23], v[72:87]
    v_fma_f32 v92, v92, s42, -v8
    v_fma_f32 v93, v93, s42, -v8
    v_exp_f32 v92, v92
    v_exp_f32 v93, v93
    ds_read_b128 v[52:55], v25 offset:33024
    s_waitcnt lgkmcnt(7)
    v_mfma_f32_32x32x16_bf16 v[72:87], v[56:59], a[24:27], v[72:87]
    v_fma_f32 v94, v94, s42, -v8
    v_fma_f32 v95, v95, s42, -v8
    v_exp_f32 v94, v94
    v_exp_f32 v95, v95
    ds_read_b128 v[56:59], v26 offset:33024
    s_waitcnt lgkmcnt(7)
    v_mfma_f32_32x32x16_bf16 v[72:87], v[60:63], a[28:31], v[72:87]
    v_fma_f32 v96, v96, s42, -v8
    v_fma_f32 v97, v97, s42, -v8
    v_exp_f32 v96, v96
    v_exp_f32 v97, v97
    ds_read_b128 v[60:63], v27 offset:33024
    s_waitcnt lgkmcnt(7)
    v_mfma_f32_32x32x16_bf16 v[72:87], v[32:35], a[32:35], v[72:87]
    v_fma_f32 v98, v98, s42, -v8
    v_fma_f32 v99, v99, s42, -v8
    v_exp_f32 v98, v98
    v_exp_f32 v99, v99
    s_waitcnt lgkmcnt(6)
    v_mfma_f32_32x32x16_bf16 v[72:87], v[36:39], a[36:39], v[72:87]
    v_fma_f32 v100, v100, s42, -v8
    v_fma_f32 v101, v101, s42, -v8
    v_exp_f32 v100, v100
    v_exp_f32 v101, v101
    s_waitcnt lgkmcnt(5)
    v_mfma_f32_32x32x16_bf16 v[72:87], v[40:43], a[40:43], v[72:87]
    v_fma_f32 v102, v102, s42, -v8
    v_fma_f32 v103, v103, s42, -v8
    v_exp_f32 v102, v102
    v_exp_f32 v103, v103
    s_waitcnt lgkmcnt(4)
    v_mfma_f32_32x32x16_bf16 v[72:87], v[44:47], a[44:47], v[72:87]
    v_add_f32 v2, v88, v89
    v_add_f32 v3, v90, v91
    v_add_f32 v4, v92, v93
    v_add_f32 v5, v94, v95
    v_add_f32 v2, v2, v3
    v_add_f32 v4, v4, v5
    v_add_f32 v7, v7, v2
    v_add_f32 v7, v7, v4
    s_waitcnt lgkmcnt(3)
    v_mfma_f32_32x32x16_bf16 v[72:87], v[48:51], a[48:51], v[72:87]
    v_add_f32 v2, v96, v97
    v_add_f32 v3, v98, v99
    v_add_f32 v4, v100, v101
    v_add_f32 v5, v102, v103
    v_add_f32 v2, v2, v3
    v_add_f32 v4, v4, v5
    v_add_f32 v7, v7, v2
    v_add_f32 v7, v7, v4
    s_waitcnt lgkmcnt(2)
    v_mfma_f32_32x32x16_bf16 v[72:87], v[52:55], a[52:55], v[72:87]
    v_cvt_pk_bf16_f32 v64, v88, v89
    v_cvt_pk_bf16_f32 v65, v90, v91
    v_cvt_pk_bf16_f32 v66, v92, v93
    v_cvt_pk_bf16_f32 v67, v94, v95
    s_waitcnt lgkmcnt(1)
    v_mfma_f32_32x32x16_bf16 v[72:87], v[56:59], a[56:59], v[72:87]
    v_cvt_pk_bf16_f32 v68, v96, v97
    v_cvt_pk_bf16_f32 v69, v98, v99
    v_cvt_pk_bf16_f32 v70, v100, v101
    v_cvt_pk_bf16_f32 v71, v102, v103
    s_waitcnt lgkmcnt(0)
    v_mfma_f32_32x32x16_bf16 v[72:87], v[60:63], a[60:63], v[72:87]
    s_nop 1
    ds_read_b64_tr_b16 v[104:105], v28 offset:16384
    ds_read_b64_tr_b16 v[106:107], v28 offset:20480
    ds_read_b64_tr_b16 v[108:109], v29 offset:16384
    ds_read_b64_tr_b16 v[110:111], v29 offset:20480
    ds_read_b64_tr_b16 v[112:113], v30 offset:16384
    ds_read_b64_tr_b16 v[114:115], v30 offset:20480
    ds_read_b64_tr_b16 v[116:117], v31 offset:16384
    ds_read_b64_tr_b16 v[118:119], v31 offset:20480
    ds_read_b64_tr_b16 v[120:121], v28 offset:16640
    ds_read_b64_tr_b16 v[122:123], v28 offset:20736
    ds_read_b64_tr_b16 v[124:125], v29 offset:16640
    ds_read_b64_tr_b16 v[126:127], v29 offset:20736
    s_waitcnt lgkmcnt(10)
    v_mfma_f32_32x32x16_bf16 v[128:143], v[104:107], v[64:67], v[128:143]
    ds_read_b64_tr_b16 v[104:105], v30 offset:16640
    ds_read_b64_tr_b16 v[106:107], v30 offset:20736
    s_waitcnt lgkmcnt(10)
    v_mfma_f32_32x32x16_bf16 v[144:159], v[108:111], v[64:67], v[144:159]
    ds_read_b64_tr_b16 v[108:109], v31 offset:16640
    ds_read_b64_tr_b16 v[110:111], v31 offset:20736
    s_waitcnt lgkmcnt(10)
    v_mfma_f32_32x32x16_bf16 v[160:175], v[112:115], v[64:67], v[160:175]
    ds_read_b64_tr_b16 v[112:113], v28 offset:24576
    ds_read_b64_tr_b16 v[114:115], v28 offset:28672
    s_waitcnt lgkmcnt(10)
    v_mfma_f32_32x32x16_bf16 v[176:191], v[116:119], v[64:67], v[176:191]
    ds_read_b64_tr_b16 v[116:117], v29 offset:24576
    ds_read_b64_tr_b16 v[118:119], v29 offset:28672
    s_waitcnt lgkmcnt(10)
    v_mfma_f32_32x32x16_bf16 v[192:207], v[120:123], v[64:67], v[192:207]
    ds_read_b64_tr_b16 v[120:121], v30 offset:24576
    ds_read_b64_tr_b16 v[122:123], v30 offset:28672
    s_waitcnt lgkmcnt(10)
    v_mfma_f32_32x32x16_bf16 v[208:223], v[124:127], v[64:67], v[208:223]
    ds_read_b64_tr_b16 v[124:125], v31 offset:24576
    ds_read_b64_tr_b16 v[126:127], v31 offset:28672
    s_waitcnt lgkmcnt(10)
    v_mfma_f32_32x32x16_bf16 v[224:239], v[104:107], v[64:67], v[224:239]
    ds_read_b64_tr_b16 v[104:105], v28 offset:24832
    ds_read_b64_tr_b16 v[106:107], v28 offset:28928
    s_waitcnt lgkmcnt(10)
    v_mfma_f32_32x32x16_bf16 v[240:255], v[108:111], v[64:67], v[240:255]
    ds_read_b64_tr_b16 v[108:109], v29 offset:24832
    ds_read_b64_tr_b16 v[110:111], v29 offset:28928
    s_waitcnt lgkmcnt(10)
    v_mfma_f32_32x32x16_bf16 v[128:143], v[112:115], v[68:71], v[128:143]
    ds_read_b64_tr_b16 v[112:113], v30 offset:24832
    ds_read_b64_tr_b16 v[114:115], v30 offset:28928
    s_waitcnt lgkmcnt(10)
    v_mfma_f32_32x32x16_bf16 v[144:159], v[116:119], v[68:71], v[144:159]
    ds_read_b64_tr_b16 v[116:117], v31 offset:24832
    ds_read_b64_tr_b16 v[118:119], v31 offset:28928
    s_waitcnt lgkmcnt(10)
    v_mfma_f32_32x32x16_bf16 v[160:175], v[120:123], v[68:71], v[160:175]
    s_waitcnt lgkmcnt(8)
    v_mfma_f32_32x32x16_bf16 v[176:191], v[124:127], v[68:71], v[176:191]
    s_waitcnt lgkmcnt(6)
    v_mfma_f32_32x32x16_bf16 v[192:207], v[104:107], v[68:71], v[192:207]
    s_waitcnt lgkmcnt(4)
    v_mfma_f32_32x32x16_bf16 v[208:223], v[108:111], v[68:71], v[208:223]
    s_waitcnt lgkmcnt(2)
    v_mfma_f32_32x32x16_bf16 v[224:239], v[112:115], v[68:71], v[224:239]
    s_waitcnt lgkmcnt(0)
    v_mfma_f32_32x32x16_bf16 v[240:255], v[116:119], v[68:71], v[240:255]
    s_add_u32 s44, s44, 1
    s_cmp_lt_u32 s44, 8
    s_cbranch_scc1 L_attn_loop
    s_nop 7
    s_nop 7
    v_mov_b32 v2, v7
    v_mov_b32 v3, v7
    s_nop 1
    v_permlane32_swap_b32 v2, v3
    s_nop 1
    v_add_f32 v2, v2, v3
    v_rcp_f32 v2, v2
    s_nop 0
    v_mul_f32 v128, v2, v128
    v_mul_f32 v129, v2, v129
    v_mul_f32 v130, v2, v130
    v_mul_f32 v131, v2, v131
    v_mul_f32 v132, v2, v132
    v_mul_f32 v133, v2, v133
    v_mul_f32 v134, v2, v134
    v_mul_f32 v135, v2, v135
    v_cvt_pk_bf16_f32 v32, v128, v129
    v_cvt_pk_bf16_f32 v33, v130, v131
    v_cvt_pk_bf16_f32 v34, v132, v133
    v_cvt_pk_bf16_f32 v35, v134, v135
    s_mov_b32 s47, 0
    buffer_store_dwordx4 v[32:35], v11, s[24:27], s47 offen
    v_mul_f32 v136, v2, v136
    v_mul_f32 v137, v2, v137
    v_mul_f32 v138, v2, v138
    v_mul_f32 v139, v2, v139
    v_mul_f32 v140, v2, v140
    v_mul_f32 v141, v2, v141
    v_mul_f32 v142, v2, v142
    v_mul_f32 v143, v2, v143
    v_cvt_pk_bf16_f32 v36, v136, v137
    v_cvt_pk_bf16_f32 v37, v138, v139
    v_cvt_pk_bf16_f32 v38, v140, v141
    v_cvt_pk_bf16_f32 v39, v142, v143
    s_mov_b32 s47, 1024
    buffer_store_dwordx4 v[36:39], v11, s[24:27], s47 offen
    v_mul_f32 v144, v2, v144
    v_mul_f32 v145, v2, v145
    v_mul_f32 v146, v2, v146
    v_mul_f32 v147, v2, v147
    v_mul_f32 v148, v2, v148
    v_mul_f32 v149, v2, v149
    v_mul_f32 v150, v2, v150
    v_mul_f32 v151, v2, v151
    v_cvt_pk_bf16_f32 v40, v144, v145
    v_cvt_pk_bf16_f32 v41, v146, v147
    v_cvt_pk_bf16_f32 v42, v148, v149
    v_cvt_pk_bf16_f32 v43, v150, v151
    s_mov_b32 s47, 2048
    buffer_store_dwordx4 v[40:43], v11, s[24:27], s47 offen
    v_mul_f32 v152, v2, v152
    v_mul_f32 v153, v2, v153
    v_mul_f32 v154, v2, v154
    v_mul_f32 v155, v2, v155
    v_mul_f32 v156, v2, v156
    v_mul_f32 v157, v2, v157
    v_mul_f32 v158, v2, v158
    v_mul_f32 v159, v2, v159
    v_cvt_pk_bf16_f32 v44, v152, v153
    v_cvt_pk_bf16_f32 v45, v154, v155
    v_cvt_pk_bf16_f32 v46, v156, v157
    v_cvt_pk_bf16_f32 v47, v158, v159
    s_mov_b32 s47, 3072
    buffer_store_dwordx4 v[44:47], v11, s[24:27], s47 offen
    v_mul_f32 v160, v2, v160
    v_mul_f32 v161, v2, v161
    v_mul_f32 v162, v2, v162
    v_mul_f32 v163, v2, v163
    v_mul_f32 v164, v2, v164
    v_mul_f32 v165, v2, v165
    v_mul_f32 v166, v2, v166
    v_mul_f32 v167, v2, v167
    v_cvt_pk_bf16_f32 v32, v160, v161
    v_cvt_pk_bf16_f32 v33, v162, v163
    v_cvt_pk_bf16_f32 v34, v164, v165
    v_cvt_pk_bf16_f32 v35, v166, v167
    s_mov_b32 s47, 4096
    buffer_store_dwordx4 v[32:35], v11, s[24:27], s47 offen
    v_mul_f32 v168, v2, v168
    v_mul_f32 v169, v2, v169
    v_mul_f32 v170, v2, v170
    v_mul_f32 v171, v2, v171
    v_mul_f32 v172, v2, v172
    v_mul_f32 v173, v2, v173
    v_mul_f32 v174, v2, v174
    v_mul_f32 v175, v2, v175
    v_cvt_pk_bf16_f32 v36, v168, v169
    v_cvt_pk_bf16_f32 v37, v170, v171
    v_cvt_pk_bf16_f32 v38, v172, v173
    v_cvt_pk_bf16_f32 v39, v174, v175
    s_mov_b32 s47, 5120
    buffer_store_dwordx4 v[36:39], v11, s[24:27], s47 offen
    v_mul_f32 v176, v2, v176
    v_mul_f32 v177, v2, v177
    v_mul_f32 v178, v2, v178
    v_mul_f32 v179, v2, v179
    v_mul_f32 v180, v2, v180
    v_mul_f32 v181, v2, v181
    v_mul_f32 v182, v2, v182
    v_mul_f32 v183, v2, v183
    v_cvt_pk_bf16_f32 v40, v176, v177
    v_cvt_pk_bf16_f32 v41, v178, v179
    v_cvt_pk_bf16_f32 v42, v180, v181
    v_cvt_pk_bf16_f32 v43, v182, v183
    s_mov_b32 s47, 6144
    buffer_store_dwordx4 v[40:43], v11, s[24:27], s47 offen
    v_mul_f32 v184, v2, v184
    v_mul_f32 v185, v2, v185
    v_mul_f32 v186, v2, v186
    v_mul_f32 v187, v2, v187
    v_mul_f32 v188, v2, v188
    v_mul_f32 v189, v2, v189
    v_mul_f32 v190, v2, v190
    v_mul_f32 v191, v2, v191
    v_cvt_pk_bf16_f32 v44, v184, v185
    v_cvt_pk_bf16_f32 v45, v186, v187
    v_cvt_pk_bf16_f32 v46, v188, v189
    v_cvt_pk_bf16_f32 v47, v190, v191
    s_mov_b32 s47, 7168
    buffer_store_dwordx4 v[44:47], v11, s[24:27], s47 offen
    v_mul_f32 v192, v2, v192
    v_mul_f32 v193, v2, v193
    v_mul_f32 v194, v2, v194
    v_mul_f32 v195, v2, v195
    v_mul_f32 v196, v2, v196
    v_mul_f32 v197, v2, v197
    v_mul_f32 v198, v2, v198
    v_mul_f32 v199, v2, v199
    v_cvt_pk_bf16_f32 v32, v192, v193
    v_cvt_pk_bf16_f32 v33, v194, v195
    v_cvt_pk_bf16_f32 v34, v196, v197
    v_cvt_pk_bf16_f32 v35, v198, v199
    s_mov_b32 s47, 8192
    buffer_store_dwordx4 v[32:35], v11, s[24:27], s47 offen
    v_mul_f32 v200, v2, v200
    v_mul_f32 v201, v2, v201
    v_mul_f32 v202, v2, v202
    v_mul_f32 v203, v2, v203
    v_mul_f32 v204, v2, v204
    v_mul_f32 v205, v2, v205
    v_mul_f32 v206, v2, v206
    v_mul_f32 v207, v2, v207
    v_cvt_pk_bf16_f32 v36, v200, v201
    v_cvt_pk_bf16_f32 v37, v202, v203
    v_cvt_pk_bf16_f32 v38, v204, v205
    v_cvt_pk_bf16_f32 v39, v206, v207
    s_mov_b32 s47, 9216
    buffer_store_dwordx4 v[36:39], v11, s[24:27], s47 offen
    v_mul_f32 v208, v2, v208
    v_mul_f32 v209, v2, v209
    v_mul_f32 v210, v2, v210
    v_mul_f32 v211, v2, v211
    v_mul_f32 v212, v2, v212
    v_mul_f32 v213, v2, v213
    v_mul_f32 v214, v2, v214
    v_mul_f32 v215, v2, v215
    v_cvt_pk_bf16_f32 v40, v208, v209
    v_cvt_pk_bf16_f32 v41, v210, v211
    v_cvt_pk_bf16_f32 v42, v212, v213
    v_cvt_pk_bf16_f32 v43, v214, v215
    s_mov_b32 s47, 10240
    buffer_store_dwordx4 v[40:43], v11, s[24:27], s47 offen
    v_mul_f32 v216, v2, v216
    v_mul_f32 v217, v2, v217
    v_mul_f32 v218, v2, v218
    v_mul_f32 v219, v2, v219
    v_mul_f32 v220, v2, v220
    v_mul_f32 v221, v2, v221
    v_mul_f32 v222, v2, v222
    v_mul_f32 v223, v2, v223
    v_cvt_pk_bf16_f32 v44, v216, v217
    v_cvt_pk_bf16_f32 v45, v218, v219
    v_cvt_pk_bf16_f32 v46, v220, v221
    v_cvt_pk_bf16_f32 v47, v222, v223
    s_mov_b32 s47, 11264
    buffer_store_dwordx4 v[44:47], v11, s[24:27], s47 offen
    v_mul_f32 v224, v2, v224
    v_mul_f32 v225, v2, v225
    v_mul_f32 v226, v2, v226
    v_mul_f32 v227, v2, v227
    v_mul_f32 v228, v2, v228
    v_mul_f32 v229, v2, v229
    v_mul_f32 v230, v2, v230
    v_mul_f32 v231, v2, v231
    v_cvt_pk_bf16_f32 v32, v224, v225
    v_cvt_pk_bf16_f32 v33, v226, v227
    v_cvt_pk_bf16_f32 v34, v228, v229
    v_cvt_pk_bf16_f32 v35, v230, v231
    s_mov_b32 s47, 12288
    buffer_store_dwordx4 v[32:35], v11, s[24:27], s47 offen
    v_mul_f32 v232, v2, v232
    v_mul_f32 v233, v2, v233
    v_mul_f32 v234, v2, v234
    v_mul_f32 v235, v2, v235
    v_mul_f32 v236, v2, v236
    v_mul_f32 v237, v2, v237
    v_mul_f32 v238, v2, v238
    v_mul_f32 v239, v2, v239
    v_cvt_pk_bf16_f32 v36, v232, v233
    v_cvt_pk_bf16_f32 v37, v234, v235
    v_cvt_pk_bf16_f32 v38, v236, v237
    v_cvt_pk_bf16_f32 v39, v238, v239
    s_mov_b32 s47, 13312
    buffer_store_dwordx4 v[36:39], v11, s[24:27], s47 offen
    v_mul_f32 v240, v2, v240
    v_mul_f32 v241, v2, v241
    v_mul_f32 v242, v2, v242
    v_mul_f32 v243, v2, v243
    v_mul_f32 v244, v2, v244
    v_mul_f32 v245, v2, v245
    v_mul_f32 v246, v2, v246
    v_mul_f32 v247, v2, v247
    v_cvt_pk_bf16_f32 v40, v240, v241
    v_cvt_pk_bf16_f32 v41, v242, v243
    v_cvt_pk_bf16_f32 v42, v244, v245
    v_cvt_pk_bf16_f32 v43, v246, v247
    s_mov_b32 s47, 14336
    buffer_store_dwordx4 v[40:43], v11, s[24:27], s47 offen
    v_mul_f32 v248, v2, v248
    v_mul_f32 v249, v2, v249
    v_mul_f32 v250, v2, v250
    v_mul_f32 v251, v2, v251
    v_mul_f32 v252, v2, v252
    v_mul_f32 v253, v2, v253
    v_mul_f32 v254, v2, v254
    v_mul_f32 v255, v2, v255
    v_cvt_pk_bf16_f32 v44, v248, v249
    v_cvt_pk_bf16_f32 v45, v250, v251
    v_cvt_pk_bf16_f32 v46, v252, v253
    v_cvt_pk_bf16_f32 v47, v254, v255
    s_mov_b32 s47, 15360
    buffer_store_dwordx4 v[44:47], v11, s[24:27], s47 offen
    s_waitcnt vmcnt(0)
    s_branch L_attn_end
L_loader:
    s_add_u32 s45, s46, 65536
    s_mov_b32 m0, s45
    s_mov_b32 s47, 0
    buffer_load_dwordx4 v18, s[8:11], s47 offen offset:0 lds
    s_mov_b32 s47, 15360
    buffer_load_dwordx4 v19, s[8:11], s47 offen offset:1024 lds
    s_mov_b32 s47, 30720
    buffer_load_dwordx4 v18, s[8:11], s47 offen offset:2048 lds
    s_mov_b32 s47, 46080
    buffer_load_dwordx4 v19, s[8:11], s47 offen offset:3072 lds
    s_add_u32 s45, s46, 81920
    s_mov_b32 m0, s45
    s_mov_b32 s47, 262144
    buffer_load_dwordx4 v18, s[8:11], s47 offen offset:0 lds
    s_mov_b32 s47, 277504
    buffer_load_dwordx4 v19, s[8:11], s47 offen offset:1024 lds
    s_mov_b32 s47, 292864
    buffer_load_dwordx4 v18, s[8:11], s47 offen offset:2048 lds
    s_mov_b32 s47, 308224
    buffer_load_dwordx4 v19, s[8:11], s47 offen offset:3072 lds
    s_add_u32 s45, s46, 98304
    s_mov_b32 m0, s45
    s_mov_b32 s47, 524288
    buffer_load_dwordx4 v18, s[8:11], s47 offen offset:0 lds
    s_mov_b32 s47, 539648
    buffer_load_dwordx4 v19, s[8:11], s47 offen offset:1024 lds
    s_mov_b32 s47, 555008
    buffer_load_dwordx4 v18, s[8:11], s47 offen offset:2048 lds
    s_mov_b32 s47, 570368
    buffer_load_dwordx4 v19, s[8:11], s47 offen offset:3072 lds
    s_add_u32 s45, s46, 114688
    s_mov_b32 m0, s45
    s_mov_b32 s47, 786432
    buffer_load_dwordx4 v18, s[8:11], s47 offen offset:0 lds
    s_mov_b32 s47, 801792
    buffer_load_dwordx4 v19, s[8:11], s47 offen offset:1024 lds
    s_mov_b32 s47, 817152
    buffer_load_dwordx4 v18, s[8:11], s47 offen offset:2048 lds
    s_mov_b32 s47, 832512
    buffer_load_dwordx4 v19, s[8:11], s47 offen offset:3072 lds
    s_add_u32 s45, s46, 0
    s_mov_b32 m0, s45
    s_mov_b32 s47, 1048576
    buffer_load_dwordx4 v18, s[8:11], s47 offen offset:0 lds
    s_mov_b32 s47, 1063936
    buffer_load_dwordx4 v19, s[8:11], s47 offen offset:1024 lds
    s_mov_b32 s47, 1079296
    buffer_load_dwordx4 v18, s[8:11], s47 offen offset:2048 lds
    s_mov_b32 s47, 1094656
    buffer_load_dwordx4 v19, s[8:11], s47 offen offset:3072 lds
    s_add_u32 s45, s46, 16384
    s_mov_b32 m0, s45
    s_mov_b32 s47, 1310720
    buffer_load_dwordx4 v18, s[8:11], s47 offen offset:0 lds
    s_mov_b32 s47, 1326080
    buffer_load_dwordx4 v19, s[8:11], s47 offen offset:1024 lds
    s_mov_b32 s47, 1341440
    buffer_load_dwordx4 v18, s[8:11], s47 offen offset:2048 lds
    s_mov_b32 s47, 1356800
    buffer_load_dwordx4 v19, s[8:11], s47 offen offset:3072 lds
    s_add_u32 s45, s46, 32768
    s_mov_b32 m0, s45
    s_mov_b32 s47, 1572864
    buffer_load_dwordx4 v18, s[8:11], s47 offen offset:0 lds
    s_mov_b32 s47, 1588224
    buffer_load_dwordx4 v19, s[8:11], s47 offen offset:1024 lds
    s_mov_b32 s47, 1603584
    buffer_load_dwordx4 v18, s[8:11], s47 offen offset:2048 lds
    s_mov_b32 s47, 1618944
    buffer_load_dwordx4 v19, s[8:11], s47 offen offset:3072 lds
    s_waitcnt vmcnt(24) lgkmcnt(0)
    s_barrier
    s_add_u32 s45, s46, 49152
    s_mov_b32 m0, s45
    s_mov_b32 s47, 1835008
    buffer_load_dwordx4 v18, s[8:11], s47 offen offset:0 lds
    s_mov_b32 s47, 1850368
    buffer_load_dwordx4 v19, s[8:11], s47 offen offset:1024 lds
    s_mov_b32 s47, 1865728
    buffer_load_dwordx4 v18, s[8:11], s47 offen offset:2048 lds
    s_mov_b32 s47, 1881088
    buffer_load_dwordx4 v19, s[8:11], s47 offen offset:3072 lds
    s_waitcnt vmcnt(24) lgkmcnt(0)
    s_barrier
    s_add_u32 s45, s46, 65536
    s_mov_b32 m0, s45
    s_mov_b32 s47, 2097152
    buffer_load_dwordx4 v18, s[8:11], s47 offen offset:0 lds
    s_mov_b32 s47, 2112512
    buffer_load_dwordx4 v19, s[8:11], s47 offen offset:1024 lds
    s_mov_b32 s47, 2127872
    buffer_load_dwordx4 v18, s[8:11], s47 offen offset:2048 lds
    s_mov_b32 s47, 2143232
    buffer_load_dwordx4 v19, s[8:11], s47 offen offset:3072 lds
    s_waitcnt vmcnt(24) lgkmcnt(0)
    s_barrier
    s_add_u32 s45, s46, 81920
    s_mov_b32 m0, s45
    s_mov_b32 s47, 2359296
    buffer_load_dwordx4 v18, s[8:11], s47 offen offset:0 lds
    s_mov_b32 s47, 2374656
    buffer_load_dwordx4 v19, s[8:11], s47 offen offset:1024 lds
    s_mov_b32 s47, 2390016
    buffer_load_dwordx4 v18, s[8:11], s47 offen offset:2048 lds
    s_mov_b32 s47, 2405376
    buffer_load_dwordx4 v19, s[8:11], s47 offen offset:3072 lds
    s_waitcnt vmcnt(24) lgkmcnt(0)
    s_barrier
    s_add_u32 s45, s46, 98304
    s_mov_b32 m0, s45
    s_mov_b32 s47, 2621440
    buffer_load_dwordx4 v18, s[8:11], s47 offen offset:0 lds
    s_mov_b32 s47, 2636800
    buffer_load_dwordx4 v19, s[8:11], s47 offen offset:1024 lds
    s_mov_b32 s47, 2652160
    buffer_load_dwordx4 v18, s[8:11], s47 offen offset:2048 lds
    s_mov_b32 s47, 2667520
    buffer_load_dwordx4 v19, s[8:11], s47 offen offset:3072 lds
    s_waitcnt vmcnt(24) lgkmcnt(0)
    s_barrier
    s_add_u32 s45, s46, 114688
    s_mov_b32 m0, s45
    s_mov_b32 s47, 2883584
    buffer_load_dwordx4 v18, s[8:11], s47 offen offset:0 lds
    s_mov_b32 s47, 2898944
    buffer_load_dwordx4 v19, s[8:11], s47 offen offset:1024 lds
    s_mov_b32 s47, 2914304
    buffer_load_dwordx4 v18, s[8:11], s47 offen offset:2048 lds
    s_mov_b32 s47, 2929664
    buffer_load_dwordx4 v19, s[8:11], s47 offen offset:3072 lds
    s_waitcnt vmcnt(24) lgkmcnt(0)
    s_barrier
    s_add_u32 s45, s46, 0
    s_mov_b32 m0, s45
    s_mov_b32 s47, 3145728
    buffer_load_dwordx4 v18, s[8:11], s47 offen offset:0 lds
    s_mov_b32 s47, 3161088
    buffer_load_dwordx4 v19, s[8:11], s47 offen offset:1024 lds
    s_mov_b32 s47, 3176448
    buffer_load_dwordx4 v18, s[8:11], s47 offen offset:2048 lds
    s_mov_b32 s47, 3191808
    buffer_load_dwordx4 v19, s[8:11], s47 offen offset:3072 lds
    s_waitcnt vmcnt(24) lgkmcnt(0)
    s_barrier
    s_add_u32 s45, s46, 16384
    s_mov_b32 m0, s45
    s_mov_b32 s47, 3407872
    buffer_load_dwordx4 v18, s[8:11], s47 offen offset:0 lds
    s_mov_b32 s47, 3423232
    buffer_load_dwordx4 v19, s[8:11], s47 offen offset:1024 lds
    s_mov_b32 s47, 3438592
    buffer_load_dwordx4 v18, s[8:11], s47 offen offset:2048 lds
    s_mov_b32 s47, 3453952
    buffer_load_dwordx4 v19, s[8:11], s47 offen offset:3072 lds
    s_waitcnt vmcnt(24) lgkmcnt(0)
    s_barrier
    s_waitcnt vmcnt(20) lgkmcnt(0)
    s_barrier
    s_waitcnt vmcnt(16) lgkmcnt(0)
    s_barrier
    s_waitcnt vmcnt(12) lgkmcnt(0)
    s_barrier
    s_waitcnt vmcnt(8) lgkmcnt(0)
    s_barrier
    s_waitcnt vmcnt(4) lgkmcnt(0)
    s_barrier
    s_waitcnt vmcnt(0) lgkmcnt(0)
    s_barrier
    s_barrier
    s_add_u32 s45, s46, 32768
    s_mov_b32 m0, s45
    s_nop 0
    buffer_load_dwordx4 v12, s[12:15], s43 offen offset:0 lds
    buffer_load_dwordx4 v13, s[12:15], s43 offen offset:1024 lds
    buffer_load_dwordx4 v14, s[12:15], s43 offen offset:2048 lds
    buffer_load_dwordx4 v15, s[12:15], s43 offen offset:3072 lds
    s_add_u32 s45, s46, 98304
    s_mov_b32 m0, s45
    s_nop 0
    buffer_load_dwordx4 v16, s[16:19], s43 offen offset:0 lds
    buffer_load_dwordx4 v17, s[16:19], s43 offen offset:1024 lds
    buffer_load_dwordx4 v16, s[16:19], s43 offen offset:2048 lds
    buffer_load_dwordx4 v17, s[16:19], s43 offen offset:3072 lds
    s_add_u32 s43, s43, 16384
    s_add_u32 s45, s46, 49152
    s_mov_b32 m0, s45
    s_nop 0
    buffer_load_dwordx4 v12, s[12:15], s43 offen offset:0 lds
    buffer_load_dwordx4 v13, s[12:15], s43 offen offset:1024 lds
    buffer_load_dwordx4 v14, s[12:15], s43 offen offset:2048 lds
    buffer_load_dwordx4 v15, s[12:15], s43 offen offset:3072 lds
    s_add_u32 s45, s46, 114688
    s_mov_b32 m0, s45
    s_nop 0
    buffer_load_dwordx4 v16, s[16:19], s43 offen offset:0 lds
    buffer_load_dwordx4 v17, s[16:19], s43 offen offset:1024 lds
    buffer_load_dwordx4 v16, s[16:19], s43 offen offset:2048 lds
    buffer_load_dwordx4 v17, s[16:19], s43 offen offset:3072 lds
    s_add_u32 s43, s43, 16384
    s_add_u32 s45, s46, 0
    s_mov_b32 m0, s45
    s_nop 0
    buffer_load_dwordx4 v12, s[12:15], s43 offen offset:0 lds
    buffer_load_dwordx4 v13, s[12:15], s43 offen offset:1024 lds
    buffer_load_dwordx4 v14, s[12:15], s43 offen offset:2048 lds
    buffer_load_dwordx4 v15, s[12:15], s43 offen offset:3072 lds
    s_add_u32 s45, s46, 65536
    s_mov_b32 m0, s45
    s_nop 0
    buffer_load_dwordx4 v16, s[16:19], s43 offen offset:0 lds
    buffer_load_dwordx4 v17, s[16:19], s43 offen offset:1024 lds
    buffer_load_dwordx4 v16, s[16:19], s43 offen offset:2048 lds
    buffer_load_dwordx4 v17, s[16:19], s43 offen offset:3072 lds
    s_add_u32 s43, s43, 16384
    s_mov_b32 s44, 0
    s_waitcnt vmcnt(16) lgkmcnt(0)
    s_barrier
L_loader_loop:
    s_waitcnt vmcnt(8) lgkmcnt(0)
    s_barrier
    s_add_u32 s45, s46, 16384
    s_mov_b32 m0, s45
    s_nop 0
    buffer_load_dwordx4 v12, s[12:15], s43 offen offset:0 lds
    buffer_load_dwordx4 v13, s[12:15], s43 offen offset:1024 lds
    buffer_load_dwordx4 v14, s[12:15], s43 offen offset:2048 lds
    buffer_load_dwordx4 v15, s[12:15], s43 offen offset:3072 lds
    s_add_u32 s45, s46, 81920
    s_mov_b32 m0, s45
    s_nop 0
    buffer_load_dwordx4 v16, s[16:19], s43 offen offset:0 lds
    buffer_load_dwordx4 v17, s[16:19], s43 offen offset:1024 lds
    buffer_load_dwordx4 v16, s[16:19], s43 offen offset:2048 lds
    buffer_load_dwordx4 v17, s[16:19], s43 offen offset:3072 lds
    s_add_u32 s43, s43, 16384
    s_waitcnt vmcnt(8) lgkmcnt(0)
    s_barrier
    s_add_u32 s45, s46, 32768
    s_mov_b32 m0, s45
    s_nop 0
    buffer_load_dwordx4 v12, s[12:15], s43 offen offset:0 lds
    buffer_load_dwordx4 v13, s[12:15], s43 offen offset:1024 lds
    buffer_load_dwordx4 v14, s[12:15], s43 offen offset:2048 lds
    buffer_load_dwordx4 v15, s[12:15], s43 offen offset:3072 lds
    s_add_u32 s45, s46, 98304
    s_mov_b32 m0, s45
    s_nop 0
    buffer_load_dwordx4 v16, s[16:19], s43 offen offset:0 lds
    buffer_load_dwordx4 v17, s[16:19], s43 offen offset:1024 lds
    buffer_load_dwordx4 v16, s[16:19], s43 offen offset:2048 lds
    buffer_load_dwordx4 v17, s[16:19], s43 offen offset:3072 lds
    s_add_u32 s43, s43, 16384
    s_waitcnt vmcnt(8) lgkmcnt(0)
    s_barrier
    s_add_u32 s45, s46, 49152
    s_mov_b32 m0, s45
    s_nop 0
    buffer_load_dwordx4 v12, s[12:15], s43 offen offset:0 lds
    buffer_load_dwordx4 v13, s[12:15], s43 offen offset:1024 lds
    buffer_load_dwordx4 v14, s[12:15], s43 offen offset:2048 lds
    buffer_load_dwordx4 v15, s[12:15], s43 offen offset:3072 lds
    s_add_u32 s45, s46, 114688
    s_mov_b32 m0, s45
    s_nop 0
    buffer_load_dwordx4 v16, s[16:19], s43 offen offset:0 lds
    buffer_load_dwordx4 v17, s[16:19], s43 offen offset:1024 lds
    buffer_load_dwordx4 v16, s[16:19], s43 offen offset:2048 lds
    buffer_load_dwordx4 v17, s[16:19], s43 offen offset:3072 lds
    s_add_u32 s43, s43, 16384
    s_waitcnt vmcnt(8) lgkmcnt(0)
    s_barrier
    s_add_u32 s45, s46, 0
    s_mov_b32 m0, s45
    s_nop 0
    buffer_load_dwordx4 v12, s[12:15], s43 offen offset:0 lds
    buffer_load_dwordx4 v13, s[12:15], s43 offen offset:1024 lds
    buffer_load_dwordx4 v14, s[12:15], s43 offen offset:2048 lds
    buffer_load_dwordx4 v15, s[12:15], s43 offen offset:3072 lds
    s_add_u32 s45, s46, 65536
    s_mov_b32 m0, s45
    s_nop 0
    buffer_load_dwordx4 v16, s[16:19], s43 offen offset:0 lds
    buffer_load_dwordx4 v17, s[16:19], s43 offen offset:1024 lds
    buffer_load_dwordx4 v16, s[16:19], s43 offen offset:2048 lds
    buffer_load_dwordx4 v17, s[16:19], s43 offen offset:3072 lds
    s_add_u32 s43, s43, 16384
    s_add_u32 s44, s44, 1
    s_cmp_lt_u32 s44, 8
    s_cbranch_scc1 L_loader_loop
    s_waitcnt vmcnt(0)
L_attn_end:
    s_endpgm
.globl oproj_kernel
.p2align 8
.type oproj_kernel,@function
oproj_kernel:
    s_cmp_ge_u32 s2, 224
    s_cbranch_scc1 L_op_end
    v_lshrrev_b32 v2, 6, v0
    v_and_b32 v1, 63, v0
    s_nop 0
    v_readfirstlane_b32 s3, v2
    s_and_b32 s5, s2, 7
    s_lshr_b32 s4, s2, 3
    s_and_b32 s4, s4, 1
    s_lshr_b32 s6, s2, 4
    s_and_b32 s6, s6, 1
    s_lshr_b32 s7, s2, 5
    s_mul_i32 s46, s4, 40
    s_add_u32 s28, s0, s46
    s_addc_u32 s29, s1, 0
    s_load_dwordx2 s[32:33], s[28:29], 32
    s_load_dwordx4 s[36:39], s[0:1], 80
    s_load_dwordx2 s[34:35], s[0:1], 96
    v_lshrrev_b32 v2, 5, v1
    v_and_b32 v3, 31, v1
    s_waitcnt lgkmcnt(0)
    s_mul_i32 s46, s6, 1835008
    s_add_u32 s8, s32, s46
    s_addc_u32 s9, s33, 0
    s_sub_u32 s10, 3670016, s46
    s_mov_b32 s11, 0x00020000
    s_lshl_b32 s46, s4, 3
    s_add_u32 s49, s46, s5
    s_mul_i32 s46, s49, 3
    s_add_u32 s46, s46, s3
    s_lshl_b32 s46, s46, 18
    s_lshl_b32 s47, s6, 17
    s_add_u32 s46, s46, s47
    s_add_u32 s24, s34, s46
    s_addc_u32 s25, s35, 0
    s_mov_b32 s26, 0x2000000
    s_mov_b32 s27, 0x00020000
    s_mul_i32 s49, s49, 7
    s_add_u32 s49, s49, s7
    s_mul_i32 s46, s49, 49152
    s_add_u32 s46, s46, 16777216
    s_add_u32 s20, s34, s46
    s_addc_u32 s21, s35, 0
    s_mov_b32 s22, 49152
    s_mov_b32 s23, 0x00020000
    s_mov_b32 s12, s36
    s_mov_b32 s13, s37
    s_mov_b32 s14, 1376256
    s_mov_b32 s15, 0x00020000
    s_mov_b32 s16, s38
    s_mov_b32 s17, s39
    s_mov_b32 s18, 256
    s_mov_b32 s19, 0x00020000
    v_lshrrev_b32 v4, 3, v1
    v_mul_u32_u24 v4, 896, v4
    v_and_b32 v5, 7, v1
    v_bfe_u32 v6, v1, 4, 1
    v_lshlrev_b32 v6, 2, v6
    v_xor_b32 v5, v5, v6
    v_lshl_add_u32 v4, v5, 4, v4
    s_lshl_b32 s46, s7, 7
    s_mul_i32 s47, s3, 14336
    s_add_u32 s46, s46, s47
    v_add_u32 v12, s46, v4
    v_bfe_u32 v6, v1, 2, 2
    v_lshl_add_u32 v7, v2, 2, v6
    v_lshlrev_b32 v7, 7, v7
    v_bfe_u32 v8, v1, 4, 1
    v_lshl_add_u32 v7, v8, 5, v7
    v_and_b32 v8, 3, v1
    v_lshl_add_u32 v7, v8, 3, v7
    v_lshrrev_b32 v8, 1, v6
    v_xor_b32 v9, 0, v8
    v_lshl_add_u32 v20, v9, 6, v7
    v_xor_b32 v9, 1, v8
    v_lshl_add_u32 v21, v9, 6, v7
    v_lshlrev_b32 v13, 4, v1
    s_mov_b32 s43, 0
    s_mov_b32 s48, 0
    s_lshl_b32 s46, s3, 11
    s_cmp_eq_u32 s3, 3
    s_cbranch_scc1 L_op_loader
    v_mov_b32 v64, 0
    v_mov_b32 v65, 0
    v_mov_b32 v66, 0
    v_mov_b32 v67, 0
    v_mov_b32 v68, 0
    v_mov_b32 v69, 0
    v_mov_b32 v70, 0
    v_mov_b32 v71, 0
    v_mov_b32 v72, 0
    v_mov_b32 v73, 0
    v_mov_b32 v74, 0
    v_mov_b32 v75, 0
    v_mov_b32 v76, 0
    v_mov_b32 v77, 0
    v_mov_b32 v78, 0
    v_mov_b32 v79, 0
    v_mov_b32 v80, 0
    v_mov_b32 v81, 0
    v_mov_b32 v82, 0
    v_mov_b32 v83, 0
    v_mov_b32 v84, 0
    v_mov_b32 v85, 0
    v_mov_b32 v86, 0
    v_mov_b32 v87, 0
    v_mov_b32 v88, 0
    v_mov_b32 v89, 0
    v_mov_b32 v90, 0
    v_mov_b32 v91, 0
    v_mov_b32 v92, 0
    v_mov_b32 v93, 0
    v_mov_b32 v94, 0
    v_mov_b32 v95, 0
    buffer_load_dwordx4 v[96:99], v13, s[24:27], s48 offen offset:0
    buffer_load_dwordx4 v[100:103], v13, s[24:27], s48 offen offset:1024
    buffer_load_dwordx4 v[104:107], v13, s[24:27], s48 offen offset:2048
    buffer_load_dwordx4 v[108:111], v13, s[24:27], s48 offen offset:3072
    s_add_u32 s48, s48, 4096
    s_add_u32 s45, s46, 0
    s_mov_b32 m0, s45
    s_add_u32 s47, s43, 0
    buffer_load_dwordx4 v12, s[8:11], s47 offen offset:0 lds
    s_add_u32 s47, s43, 6144
    buffer_load_dwordx4 v12, s[8:11], s47 offen offset:1024 lds
    s_add_u32 s43, s43, 57344
    buffer_load_dwordx4 v[112:115], v13, s[24:27], s48 offen offset:0
    buffer_load_dwordx4 v[116:119], v13, s[24:27], s48 offen offset:1024
    buffer_load_dwordx4 v[120:123], v13, s[24:27], s48 offen offset:2048
    buffer_load_dwordx4 v[124:127], v13, s[24:27], s48 offen offset:3072
    s_add_u32 s48, s48, 4096
    s_add_u32 s45, s46, 8192
    s_mov_b32 m0, s45
    s_add_u32 s47, s43, 0
    buffer_load_dwordx4 v12, s[8:11], s47 offen offset:0 lds
    s_add_u32 s47, s43, 6144
    buffer_load_dwordx4 v12, s[8:11], s47 offen offset:1024 lds
    s_add_u32 s43, s43, 57344
    s_add_u32 s45, s46, 16384
    s_mov_b32 m0, s45
    s_add_u32 s47, s43, 0
    buffer_load_dwordx4 v12, s[8:11], s47 offen offset:0 lds
    s_add_u32 s47, s43, 6144
    buffer_load_dwordx4 v12, s[8:11], s47 offen offset:1024 lds
    s_add_u32 s43, s43, 57344
    s_mov_b32 s44, 0
L_op_loop:
    s_waitcnt vmcnt(8) lgkmcnt(0)
    s_barrier
    buffer_load_dwordx4 v[128:131], v13, s[24:27], s48 offen offset:0
    buffer_load_dwordx4 v[132:135], v13, s[24:27], s48 offen offset:1024
    buffer_load_dwordx4 v[136:139], v13, s[24:27], s48 offen offset:2048
    buffer_load_dwordx4 v[140:143], v13, s[24:27], s48 offen offset:3072
    s_add_u32 s48, s48, 4096
    s_add_u32 s45, s46, 24576
    s_mov_b32 m0, s45
    s_add_u32 s47, s43, 0
    buffer_load_dwordx4 v12, s[8:11], s47 offen offset:0 lds
    s_add_u32 s47, s43, 6144
    buffer_load_dwordx4 v12, s[8:11], s47 offen offset:1024 lds
    s_add_u32 s43, s43, 57344
    ds_read_b64_tr_b16 v[32:33], v20 offset:0
    ds_read_b64_tr_b16 v[34:35], v20 offset:1024
    ds_read_b64_tr_b16 v[36:37], v21 offset:0
    ds_read_b64_tr_b16 v[38:39], v21 offset:1024
    ds_read_b64_tr_b16 v[40:41], v20 offset:2048
    ds_read_b64_tr_b16 v[42:43], v20 offset:3072
    ds_read_b64_tr_b16 v[44:45], v21 offset:2048
    ds_read_b64_tr_b16 v[46:47], v21 offset:3072
    s_waitcnt lgkmcnt(6)
    v_mfma_f32_32x32x16_bf16 v[64:79], v[32:35], v[96:99], v[64:79]
    ds_read_b64_tr_b16 v[32:33], v20 offset:4096
    ds_read_b64_tr_b16 v[34:35], v20 offset:5120
    s_waitcnt lgkmcnt(6)
    v_mfma_f32_32x32x16_bf16 v[80:95], v[36:39], v[96:99], v[80:95]
    ds_read_b64_tr_b16 v[36:37], v21 offset:4096
    ds_read_b64_tr_b16 v[38:39], v21 offset:5120
    s_waitcnt lgkmcnt(6)
    v_mfma_f32_32x32x16_bf16 v[64:79], v[40:43], v[100:103], v[64:79]
    ds_read_b64_tr_b16 v[40:41], v20 offset:6144
    ds_read_b64_tr_b16 v[42:43], v20 offset:7168
    s_waitcnt lgkmcnt(6)
    v_mfma_f32_32x32x16_bf16 v[80:95], v[44:47], v[100:103], v[80:95]
    ds_read_b64_tr_b16 v[44:45], v21 offset:6144
    ds_read_b64_tr_b16 v[46:47], v21 offset:7168
    s_waitcnt lgkmcnt(6)
    v_mfma_f32_32x32x16_bf16 v[64:79], v[32:35], v[104:107], v[64:79]
    s_waitcnt lgkmcnt(4)
    v_mfma_f32_32x32x16_bf16 v[80:95], v[36:39], v[104:107], v[80:95]
    s_waitcnt lgkmcnt(2)
    v_mfma_f32_32x32x16_bf16 v[64:79], v[40:43], v[108:111], v[64:79]
    s_waitcnt lgkmcnt(0)
    v_mfma_f32_32x32x16_bf16 v[80:95], v[44:47], v[108:111], v[80:95]
    s_waitcnt vmcnt(8) lgkmcnt(0)
    s_barrier
    buffer_load_dwordx4 v[144:147], v13, s[24:27], s48 offen offset:0
    buffer_load_dwordx4 v[148:151], v13, s[24:27], s48 offen offset:1024
    buffer_load_dwordx4 v[152:155], v13, s[24:27], s48 offen offset:2048
    buffer_load_dwordx4 v[156:159], v13, s[24:27], s48 offen offset:3072
    s_add_u32 s48, s48, 4096
    s_add_u32 s45, s46, 0
    s_mov_b32 m0, s45
    s_add_u32 s47, s43, 0
    buffer_load_dwordx4 v12, s[8:11], s47 offen offset:0 lds
    s_add_u32 s47, s43, 6144
    buffer_load_dwordx4 v12, s[8:11], s47 offen offset:1024 lds
    s_add_u32 s43, s43, 57344
    ds_read_b64_tr_b16 v[32:33], v20 offset:8192
    ds_read_b64_tr_b16 v[34:35], v20 offset:9216
    ds_read_b64_tr_b16 v[36:37], v21 offset:8192
    ds_read_b64_tr_b16 v[38:39], v21 offset:9216
    ds_read_b64_tr_b16 v[40:41], v20 offset:10240
    ds_read_b64_tr_b16 v[42:43], v20 offset:11264
    ds_read_b64_tr_b16 v[44:45], v21 offset:10240
    ds_read_b64_tr_b16 v[46:47], v21 offset:11264
    s_waitcnt lgkmcnt(6)
    v_mfma_f32_32x32x16_bf16 v[64:79], v[32:35], v[112:115], v[64:79]
    ds_read_b64_tr_b16 v[32:33], v20 offset:12288
    ds_read_b64_tr_b16 v[34:35], v20 offset:13312
    s_waitcnt lgkmcnt(6)
    v_mfma_f32_32x32x16_bf16 v[80:95], v[36:39], v[112:115], v[80:95]
    ds_read_b64_tr_b16 v[36:37], v21 offset:12288
    ds_read_b64_tr_b16 v[38:39], v21 offset:13312
    s_waitcnt lgkmcnt(6)
    v_mfma_f32_32x32x16_bf16 v[64:79], v[40:43], v[116:119], v[64:79]
    ds_read_b64_tr_b16 v[40:41], v20 offset:14336
    ds_read_b64_tr_b16 v[42:43], v20 offset:15360
    s_waitcnt lgkmcnt(6)
    v_mfma_f32_32x32x16_bf16 v[80:95], v[44:47], v[116:119], v[80:95]
    ds_read_b64_tr_b16 v[44:45], v21 offset:14336
    ds_read_b64_tr_b16 v[46:47], v21 offset:15360
    s_waitcnt lgkmcnt(6)
    v_mfma_f32_32x32x16_bf16 v[64:79], v[32:35], v[120:123], v[64:79]
    s_waitcnt lgkmcnt(4)
    v_mfma_f32_32x32x16_bf16 v[80:95], v[36:39], v[120:123], v[80:95]
    s_waitcnt lgkmcnt(2)
    v_mfma_f32_32x32x16_bf16 v[64:79], v[40:43], v[124:127], v[64:79]
    s_waitcnt lgkmcnt(0)
    v_mfma_f32_32x32x16_bf16 v[80:95], v[44:47], v[124:127], v[80:95]
    s_waitcnt vmcnt(8) lgkmcnt(0)
    s_barrier
    buffer_load_dwordx4 v[96:99], v13, s[24:27], s48 offen offset:0
    buffer_load_dwordx4 v[100:103], v13, s[24:27], s48 offen offset:1024
    buffer_load_dwordx4 v[104:107], v13, s[24:27], s48 offen offset:2048
    buffer_load_dwordx4 v[108:111], v13, s[24:27], s48 offen offset:3072
    s_add_u32 s48, s48, 4096
    s_add_u32 s45, s46, 8192
    s_mov_b32 m0, s45
    s_add_u32 s47, s43, 0
    buffer_load_dwordx4 v12, s[8:11], s47 offen offset:0 lds
    s_add_u32 s47, s43, 6144
    buffer_load_dwordx4 v12, s[8:11], s47 offen offset:1024 lds
    s_add_u32 s43, s43, 57344
    ds_read_b64_tr_b16 v[32:33], v20 offset:16384
    ds_read_b64_tr_b16 v[34:35], v20 offset:17408
    ds_read_b64_tr_b16 v[36:37], v21 offset:16384
    ds_read_b64_tr_b16 v[38:39], v21 offset:17408
    ds_read_b64_tr_b16 v[40:41], v20 offset:18432
    ds_read_b64_tr_b16 v[42:43], v20 offset:19456
    ds_read_b64_tr_b16 v[44:45], v21 offset:18432
    ds_read_b64_tr_b16 v[46:47], v21 offset:19456
    s_waitcnt lgkmcnt(6)
    v_mfma_f32_32x32x16_bf16 v[64:79], v[32:35], v[128:131], v[64:79]
    ds_read_b64_tr_b16 v[32:33], v20 offset:20480
    ds_read_b64_tr_b16 v[34:35], v20 offset:21504
    s_waitcnt lgkmcnt(6)
    v_mfma_f32_32x32x16_bf16 v[80:95], v[36:39], v[128:131], v[80:95]
    ds_read_b64_tr_b16 v[36:37], v21 offset:20480
    ds_read_b64_tr_b16 v[38:39], v21 offset:21504
    s_waitcnt lgkmcnt(6)
    v_mfma_f32_32x32x16_bf16 v[64:79], v[40:43], v[132:135], v[64:79]
    ds_read_b64_tr_b16 v[40:41], v20 offset:22528
    ds_read_b64_tr_b16 v[42:43], v20 offset:23552
    s_waitcnt lgkmcnt(6)
    v_mfma_f32_32x32x16_bf16 v[80:95], v[44:47], v[132:135], v[80:95]
    ds_read_b64_tr_b16 v[44:45], v21 offset:22528
    ds_read_b64_tr_b16 v[46:47], v21 offset:23552
    s_waitcnt lgkmcnt(6)
    v_mfma_f32_32x32x16_bf16 v[64:79], v[32:35], v[136:139], v[64:79]
    s_waitcnt lgkmcnt(4)
    v_mfma_f32_32x32x16_bf16 v[80:95], v[36:39], v[136:139], v[80:95]
    s_waitcnt lgkmcnt(2)
    v_mfma_f32_32x32x16_bf16 v[64:79], v[40:43], v[140:143], v[64:79]
    s_waitcnt lgkmcnt(0)
    v_mfma_f32_32x32x16_bf16 v[80:95], v[44:47], v[140:143], v[80:95]
    s_waitcnt vmcnt(8) lgkmcnt(0)
    s_barrier
    buffer_load_dwordx4 v[112:115], v13, s[24:27], s48 offen offset:0
    buffer_load_dwordx4 v[116:119], v13, s[24:27], s48 offen offset:1024
    buffer_load_dwordx4 v[120:123], v13, s[24:27], s48 offen offset:2048
    buffer_load_dwordx4 v[124:127], v13, s[24:27], s48 offen offset:3072
    s_add_u32 s48, s48, 4096
    s_add_u32 s45, s46, 16384
    s_mov_b32 m0, s45
    s_add_u32 s47, s43, 0
    buffer_load_dwordx4 v12, s[8:11], s47 offen offset:0 lds
    s_add_u32 s47, s43, 6144
    buffer_load_dwordx4 v12, s[8:11], s47 offen offset:1024 lds
    s_add_u32 s43, s43, 57344
    ds_read_b64_tr_b16 v[32:33], v20 offset:24576
    ds_read_b64_tr_b16 v[34:35], v20 offset:25600
    ds_read_b64_tr_b16 v[36:37], v21 offset:24576
    ds_read_b64_tr_b16 v[38:39], v21 offset:25600
    ds_read_b64_tr_b16 v[40:41], v20 offset:26624
    ds_read_b64_tr_b16 v[42:43], v20 offset:27648
    ds_read_b64_tr_b16 v[44:45], v21 offset:26624
    ds_read_b64_tr_b16 v[46:47], v21 offset:27648
    s_waitcnt lgkmcnt(6)
    v_mfma_f32_32x32x16_bf16 v[64:79], v[32:35], v[144:147], v[64:79]
    ds_read_b64_tr_b16 v[32:33], v20 offset:28672
    ds_read_b64_tr_b16 v[34:35], v20 offset:29696
    s_waitcnt lgkmcnt(6)
    v_mfma_f32_32x32x16_bf16 v[80:95], v[36:39], v[144:147], v[80:95]
    ds_read_b64_tr_b16 v[36:37], v21 offset:28672
    ds_read_b64_tr_b16 v[38:39], v21 offset:29696
    s_waitcnt lgkmcnt(6)
    v_mfma_f32_32x32x16_bf16 v[64:79], v[40:43], v[148:151], v[64:79]
    ds_read_b64_tr_b16 v[40:41], v20 offset:30720
    ds_read_b64_tr_b16 v[42:43], v20 offset:31744
    s_waitcnt lgkmcnt(6)
    v_mfma_f32_32x32x16_bf16 v[80:95], v[44:47], v[148:151], v[80:95]
    ds_read_b64_tr_b16 v[44:45], v21 offset:30720
    ds_read_b64_tr_b16 v[46:47], v21 offset:31744
    s_waitcnt lgkmcnt(6)
    v_mfma_f32_32x32x16_bf16 v[64:79], v[32:35], v[152:155], v[64:79]
    s_waitcnt lgkmcnt(4)
    v_mfma_f32_32x32x16_bf16 v[80:95], v[36:39], v[152:155], v[80:95]
    s_waitcnt lgkmcnt(2)
    v_mfma_f32_32x32x16_bf16 v[64:79], v[40:43], v[156:159], v[64:79]
    s_waitcnt lgkmcnt(0)
    v_mfma_f32_32x32x16_bf16 v[80:95], v[44:47], v[156:159], v[80:95]
    s_add_u32 s44, s44, 1
    s_cmp_lt_u32 s44, 8
    s_cbranch_scc1 L_op_loop
    s_nop 7
    s_nop 7
    s_lshl_b32 s47, s6, 0
    s_mul_i32 s47, s47, 24576
    s_lshl_b32 s48, s3, 13
    s_add_u32 s47, s47, s48
    buffer_store_dwordx4 v[64:67], v13, s[20:23], s47 offen offset:0 sc0 sc1
    buffer_store_dwordx4 v[68:71], v13, s[20:23], s47 offen offset:1024 sc0 sc1
    buffer_store_dwordx4 v[72:75], v13, s[20:23], s47 offen offset:2048 sc0 sc1
    buffer_store_dwordx4 v[76:79], v13, s[20:23], s47 offen offset:3072 sc0 sc1
    s_add_u32 s49, s47, 4096
    buffer_store_dwordx4 v[80:83], v13, s[20:23], s49 offen offset:0 sc0 sc1
    buffer_store_dwordx4 v[84:87], v13, s[20:23], s49 offen offset:1024 sc0 sc1
    buffer_store_dwordx4 v[88:91], v13, s[20:23], s49 offen offset:2048 sc0 sc1
    buffer_store_dwordx4 v[92:95], v13, s[20:23], s49 offen offset:3072 sc0 sc1
    s_branch L_op_join
L_op_loader:
    s_add_u32 s45, s46, 0
    s_mov_b32 m0, s45
    s_add_u32 s47, s43, 0
    buffer_load_dwordx4 v12, s[8:11], s47 offen offset:0 lds
    s_add_u32 s47, s43, 6144
    buffer_load_dwordx4 v12, s[8:11], s47 offen offset:1024 lds
    s_add_u32 s43, s43, 57344
    s_add_u32 s45, s46, 8192
    s_mov_b32 m0, s45
    s_add_u32 s47, s43, 0
    buffer_load_dwordx4 v12, s[8:11], s47 offen offset:0 lds
    s_add_u32 s47, s43, 6144
    buffer_load_dwordx4 v12, s[8:11], s47 offen offset:1024 lds
    s_add_u32 s43, s43, 57344
    s_add_u32 s45, s46, 16384
    s_mov_b32 m0, s45
    s_add_u32 s47, s43, 0
    buffer_load_dwordx4 v12, s[8:11], s47 offen offset:0 lds
    s_add_u32 s47, s43, 6144
    buffer_load_dwordx4 v12, s[8:11], s47 offen offset:1024 lds
    s_add_u32 s43, s43, 57344
    s_mov_b32 s44, 0
L_op_lloop:
    s_waitcnt vmcnt(4) lgkmcnt(0)
    s_barrier
    s_add_u32 s45, s46, 24576
    s_mov_b32 m0, s45
    s_add_u32 s47, s43, 0
    buffer_load_dwordx4 v12, s[8:11], s47 offen offset:0 lds
    s_add_u32 s47, s43, 6144
    buffer_load_dwordx4 v12, s[8:11], s47 offen offset:1024 lds
    s_add_u32 s43, s43, 57344
    s_waitcnt vmcnt(4) lgkmcnt(0)
    s_barrier
    s_add_u32 s45, s46, 0
    s_mov_b32 m0, s45
    s_add_u32 s47, s43, 0
    buffer_load_dwordx4 v12, s[8:11], s47 offen offset:0 lds
    s_add_u32 s47, s43, 6144
    buffer_load_dwordx4 v12, s[8:11], s47 offen offset:1024 lds
    s_add_u32 s43, s43, 57344
    s_waitcnt vmcnt(4) lgkmcnt(0)
    s_barrier
    s_add_u32 s45, s46, 8192
    s_mov_b32 m0, s45
    s_add_u32 s47, s43, 0
    buffer_load_dwordx4 v12, s[8:11], s47 offen offset:0 lds
    s_add_u32 s47, s43, 6144
    buffer_load_dwordx4 v12, s[8:11], s47 offen offset:1024 lds
    s_add_u32 s43, s43, 57344
    s_waitcnt vmcnt(4) lgkmcnt(0)
    s_barrier
    s_add_u32 s45, s46, 16384
    s_mov_b32 m0, s45
    s_add_u32 s47, s43, 0
    buffer_load_dwordx4 v12, s[8:11], s47 offen offset:0 lds
    s_add_u32 s47, s43, 6144
    buffer_load_dwordx4 v12, s[8:11], s47 offen offset:1024 lds
    s_add_u32 s43, s43, 57344
    s_add_u32 s44, s44, 1
    s_cmp_lt_u32 s44, 8
    s_cbranch_scc1 L_op_lloop
L_op_join:
    s_waitcnt vmcnt(0)
    s_barrier
    s_lshl_b32 s50, s4, 3
    s_add_u32 s50, s50, s5
    s_mul_i32 s50, s50, 7
    s_add_u32 s50, s50, s7
    s_cmp_lg_u32 s3, 0
    s_cbranch_scc1 L_op_wait
    s_and_b32 s51, s50, 3
    s_lshl_b32 s51, s51, 3
    s_lshl_b32 s52, 1, s51
    s_and_b32 s53, s50, 0xfc
    v_mov_b32 v4, s52
    v_mov_b32 v5, s53
    v_cmp_eq_u32 vcc, 0, v1
    s_and_saveexec_b64 s[60:61], vcc
    buffer_atomic_add v4, v5, s[16:19], 0 offen sc0
    s_waitcnt vmcnt(0)
    v_lshrrev_b32 v4, s51, v4
    v_and_b32 v4, 0xff, v4
    v_mov_b32 v5, 32768
    ds_write_b32 v5, v4
    s_mov_b64 exec, s[60:61]
L_op_wait:
    s_waitcnt lgkmcnt(0)
    s_barrier
    v_mov_b32 v5, 32768
    ds_read_b32 v4, v5
    s_waitcnt lgkmcnt(0)
    v_readfirstlane_b32 s51, v4
    s_nop 3
    s_cmp_eq_u32 s51, 0
    s_cbranch_scc1 L_op_end
    s_cmp_eq_u32 s3, 3
    s_cbranch_scc1 L_op_end
    s_xor_b32 s47, s6, 1
    s_mul_i32 s47, s47, 24576
    s_lshl_b32 s48, s3, 13
    s_add_u32 s47, s47, s48
    s_add_u32 s49, s47, 4096
    buffer_load_dwordx4 v[96:99], v13, s[20:23], s47 offen offset:0 sc0 sc1
    buffer_load_dwordx4 v[100:103], v13, s[20:23], s47 offen offset:1024 sc0 sc1
    buffer_load_dwordx4 v[104:107], v13, s[20:23], s47 offen offset:2048 sc0 sc1
    buffer_load_dwordx4 v[108:111], v13, s[20:23], s47 offen offset:3072 sc0 sc1
    buffer_load_dwordx4 v[112:115], v13, s[20:23], s49 offen offset:0 sc0 sc1
    buffer_load_dwordx4 v[116:119], v13, s[20:23], s49 offen offset:1024 sc0 sc1
    buffer_load_dwordx4 v[120:123], v13, s[20:23], s49 offen offset:2048 sc0 sc1
    buffer_load_dwordx4 v[124:127], v13, s[20:23], s49 offen offset:3072 sc0 sc1
    s_waitcnt vmcnt(0)
    v_add_f32 v64, v64, v96
    v_add_f32 v65, v65, v97
    v_add_f32 v66, v66, v98
    v_add_f32 v67, v67, v99
    v_add_f32 v68, v68, v100
    v_add_f32 v69, v69, v101
    v_add_f32 v70, v70, v102
    v_add_f32 v71, v71, v103
    v_add_f32 v72, v72, v104
    v_add_f32 v73, v73, v105
    v_add_f32 v74, v74, v106
    v_add_f32 v75, v75, v107
    v_add_f32 v76, v76, v108
    v_add_f32 v77, v77, v109
    v_add_f32 v78, v78, v110
    v_add_f32 v79, v79, v111
    v_add_f32 v80, v80, v112
    v_add_f32 v81, v81, v113
    v_add_f32 v82, v82, v114
    v_add_f32 v83, v83, v115
    v_add_f32 v84, v84, v116
    v_add_f32 v85, v85, v117
    v_add_f32 v86, v86, v118
    v_add_f32 v87, v87, v119
    v_add_f32 v88, v88, v120
    v_add_f32 v89, v89, v121
    v_add_f32 v90, v90, v122
    v_add_f32 v91, v91, v123
    v_add_f32 v92, v92, v124
    v_add_f32 v93, v93, v125
    v_add_f32 v94, v94, v126
    v_add_f32 v95, v95, v127
    s_mul_i32 s47, s5, 96
    s_lshl_b32 s48, s3, 5
    s_add_u32 s47, s47, s48
    v_add_u32 v4, s47, v3
    v_mul_u32_u24 v4, 1792, v4
    s_mul_i32 s47, s4, 896
    s_lshl_b32 s48, s7, 7
    s_add_u32 s47, s47, s48
    v_add_u32 v4, s47, v4
    v_lshl_add_u32 v4, v2, 3, v4
    v_cvt_pk_bf16_f32 v6, v64, v65
    v_cvt_pk_bf16_f32 v7, v66, v67
    buffer_store_dwordx2 v[6:7], v4, s[12:15], 0 offen offset:0
    s_nop 1
    v_cvt_pk_bf16_f32 v6, v68, v69
    v_cvt_pk_bf16_f32 v7, v70, v71
    buffer_store_dwordx2 v[6:7], v4, s[12:15], 0 offen offset:16
    s_nop 1
    v_cvt_pk_bf16_f32 v6, v72, v73
    v_cvt_pk_bf16_f32 v7, v74, v75
    buffer_store_dwordx2 v[6:7], v4, s[12:15], 0 offen offset:32
    s_nop 1
    v_cvt_pk_bf16_f32 v6, v76, v77
    v_cvt_pk_bf16_f32 v7, v78, v79
    buffer_store_dwordx2 v[6:7], v4, s[12:15], 0 offen offset:48
    s_nop 1
    v_cvt_pk_bf16_f32 v6, v80, v81
    v_cvt_pk_bf16_f32 v7, v82, v83
    buffer_store_dwordx2 v[6:7], v4, s[12:15], 0 offen offset:64
    s_nop 1
    v_cvt_pk_bf16_f32 v6, v84, v85
    v_cvt_pk_bf16_f32 v7, v86, v87
    buffer_store_dwordx2 v[6:7], v4, s[12:15], 0 offen offset:80
    s_nop 1
    v_cvt_pk_bf16_f32 v6, v88, v89
    v_cvt_pk_bf16_f32 v7, v90, v91
    buffer_store_dwordx2 v[6:7], v4, s[12:15], 0 offen offset:96
    s_nop 1
    v_cvt_pk_bf16_f32 v6, v92, v93
    v_cvt_pk_bf16_f32 v7, v94, v95
    buffer_store_dwordx2 v[6:7], v4, s[12:15], 0 offen offset:112
    s_nop 1
L_op_end:
    s_endpgm
.section .rodata,"a"
.p2align 6
.amdhsa_kernel concat_heads__gqa_block_cached__gqa_block_cached__near_ridge_kernel
  .amdhsa_next_free_vgpr 432
  .amdhsa_next_free_sgpr 102
  .amdhsa_accum_offset 256
  .amdhsa_group_segment_fixed_size 0
  .amdhsa_kernarg_size 104
  .amdhsa_user_sgpr_count 2
  .amdhsa_user_sgpr_kernarg_segment_ptr 1
  .amdhsa_system_sgpr_workgroup_id_x 1
.end_amdhsa_kernel
.p2align 6
.amdhsa_kernel oproj_kernel
  .amdhsa_next_free_vgpr 192
  .amdhsa_next_free_sgpr 102
  .amdhsa_accum_offset 192
  .amdhsa_group_segment_fixed_size 0
  .amdhsa_kernarg_size 104
  .amdhsa_user_sgpr_count 2
  .amdhsa_user_sgpr_kernarg_segment_ptr 1
  .amdhsa_system_sgpr_workgroup_id_x 1
.end_amdhsa_kernel
```
